```python
import torch

def _softmax(x, axis=-1):
    return torch.softmax(x, dim=axis)
def _gelu(x):
    return torch.nn.functional.gelu(x, approximate="tanh")
def _silu(x):
    return torch.nn.functional.silu(x)
def _sigmoid(x):
    return torch.sigmoid(x)
def _layernorm(x, axis=-1, eps=1e-5):
    m = x.mean(dim=axis, keepdim=True)
    v = x.var(dim=axis, keepdim=True, unbiased=False)
    return (x - m) / torch.sqrt(v + eps)
def _scatter_add(tgt, idx, src, axis=0):
    return tgt.clone().index_add_(axis, idx, src)
def _segment_sum(src, seg, n):
    out = torch.zeros((n,) + src.shape[1:], dtype=src.dtype)
    return out.index_add_(0, seg, src)
def _pad(x, pw):
    flat = tuple(v for pair in reversed(pw) for v in pair)
    return torch.nn.functional.pad(x, flat)

kernel_name = 'sequential_preLN__mha_block_cached__dense_activation_silu__decode'

def setup_inputs():

    _w = (lambda a: (lambda t: t.to(torch.bfloat16) if t.is_floating_point() else t)(torch.as_tensor(a)))
    def _A_setup():
        B, Sq, D = 2, 1, 640
        H, Sk, Dh = 32, 8192, 192
        return {
            "x": _w((lambda *s: torch.randn(*s, dtype=torch.bfloat16) * 0.05)(B, Sq, D)),
            "k_cache": _w((lambda *s: torch.randn(*s, dtype=torch.bfloat16) * 3.2)(B, H, Sk, Dh)),
            "v_cache": _w((lambda *s: torch.randn(*s, dtype=torch.bfloat16) * 0.8)(B, H, Sk, Dh)),
            "wq": _w((lambda *s: torch.randn(*s, dtype=torch.bfloat16) * 3.2)(D, H * Dh) * (D ** -0.5)),
            "wo": _w((lambda *s: torch.randn(*s, dtype=torch.bfloat16) * 0.8)(H * Dh, D) * ((H * Dh) ** -0.5)),
        }
    _A_in = _A_setup()

    def _B_setup():
        B, S, D, F = 2, 1, 640, 1536
        return {
            "x": _w((lambda *s: torch.randn(*s, dtype=torch.bfloat16) * 0.05)(B, S, D)),
            "w1": _w((lambda *s: torch.randn(*s, dtype=torch.bfloat16) * 3.2)(D, F) * (D ** -0.5)),
            "w2": _w((lambda *s: torch.randn(*s, dtype=torch.bfloat16) * 0.8)(F, D) * (F ** -0.5)),
        }
    _B_in = _B_setup()

    return {
        "A_x": _A_in["x"],
        "A_k_cache": _A_in["k_cache"],
        "A_v_cache": _A_in["v_cache"],
        "A_wq": _A_in["wq"],
        "A_wo": _A_in["wo"],
        "B_x": _B_in["x"],
        "B_w1": _B_in["w1"],
        "B_w2": _B_in["w2"],
    }

def reference(A_x, A_k_cache, A_v_cache, A_wq, A_wo, B_x, B_w1, B_w2):
    def _A_ref(x, k_cache, v_cache, wq, wo):
        B, Sq, D = x.shape
        H, Dh = 32, 192
        q = (lambda x, *d: x.permute(*d))((x @ wq).reshape(B, Sq, H, Dh), 0, 2, 1, 3)
        scores = torch.einsum("bhqd,bhkd->bhqk", q, k_cache) * (Dh ** -0.5)
        p = _softmax(scores, axis=-1)
        o = torch.einsum("bhqk,bhkd->bhqd", p, v_cache)
        return (lambda x, *d: x.permute(*d))(o, 0, 2, 1, 3).reshape(B, Sq, H * Dh) @ wo

    def _B_ref(x, w1, w2):
        h = torch.einsum("bsd,df->bsf", x, w1)
        h = _silu(h)
        out = torch.einsum("bsf,fd->bsd", h, w2)
        return out

    x = A_x
    h = x + _A_ref(_layernorm(x, axis=-1), A_k_cache, A_v_cache, A_wq, A_wo)
    h2 = h + _B_ref(_layernorm(h, axis=-1), B_w1, B_w2)
    return h2
```

```asm
; @launch grid=(256,1,1) block=(512,1,1) lds=163840
.amdgcn_target "amdgcn-amd-amdhsa--gfx950"
.text
.globl sequential_preLN__mha_block_cached__dense_activation_silu__decode_kernel
.p2align 8
.type sequential_preLN__mha_block_cached__dense_activation_silu__decode_kernel,@function
sequential_preLN__mha_block_cached__dense_activation_silu__decode_kernel:
    s_cmp_ge_u32 s2, 256
    s_cbranch_scc1 L_exit
    s_load_dwordx16 s[4:19], s[0:1], 0
    s_load_dwordx4 s[20:23], s[0:1], 64
    s_load_dwordx2 s[24:25], s[0:1], 80
    v_xor_b32 v0, 256, v0
    v_and_b32 v1, 63, v0
    v_lshrrev_b32 v2, 6, v0
    v_and_b32 v3, 7, v0
    v_readfirstlane_b32 s28, v2
    s_lshr_b32 s26, s2, 3
    s_and_b32 s27, s2, 7
    s_lshr_b32 s29, s27, 2
    s_mov_b32 s51, 0x3d93cd3a
    s_mov_b32 s52, 0x3fb8aa3b
    v_lshrrev_b32 v50, 3, v1
    v_mul_u32_u24 v62, 384, v50
    v_lshl_add_u32 v62, v3, 4, v62
    v_mov_b32 v44, 1
    v_mov_b32 v45, 0
    s_lshl_b32 s31, s29, 5
    s_add_u32 s31, s31, s26
    s_lshl_b32 s64, s31, 8
    s_add_u32 s64, s64, 4096
    s_mul_i32 s62, s31, 3145728
    s_and_b32 s47, s27, 3
    s_mul_i32 s47, s47, 88
    s_add_u32 s45, s47, s28
    s_mul_i32 s45, s45, 6144
    s_add_u32 s46, s45, 49152
    s_lshl_b32 s63, s27, 2
    s_lshr_b32 s27, 0x76435210, s63
    s_and_b32 s27, s27, 7
    s_lshr_b32 s63, 0x57743210, s63
    s_and_b32 s63, s63, 7
    s_lshr_b32 s70, s26, 1
    s_mul_i32 s70, s70, 6
    s_add_u32 s70, s70, s63
    s_cmp_lt_u32 s63, 6
    s_cselect_b32 s71, 1, 0
    v_mov_b32 v50, 28
    v_mov_b32 v51, 0
    v_mov_b32 v52, 0
    v_mov_b32 v53, 0
    s_cmp_lg_u32 s28, 4
    s_cbranch_scc1 L_noinit
    ds_write_b128 v45, v[50:53] offset:0
    ds_write_b32 v45, v45 offset:16
L_noinit:
    s_waitcnt lgkmcnt(0)
    s_load_dword s30, s[24:25], 0
    s_add_u32 s32, s6, s62
    s_addc_u32 s33, s7, 0
    s_mov_b32 s34, 3145728
    s_mov_b32 s35, 0x00020000
    s_add_u32 s36, s8, s62
    s_addc_u32 s37, s9, 0
    s_mov_b32 s38, 3145728
    s_mov_b32 s39, 0x00020000
    s_add_u32 s48, s24, s64
    s_addc_u32 s49, s25, 0
    s_mov_b64 s[14:15], -1
    s_mov_b32 s96, s28
    s_mov_b32 s60, 0
    s_mov_b32 s61, s26
    s_cmp_lt_u32 s27, 5
    s_cbranch_scc1 L_rid_done
    s_mov_b32 s60, 3
    s_cmp_lg_u32 s27, 7
    s_cbranch_scc1 L_rid_n7
    s_cmp_lt_u32 s26, 20
    s_cselect_b32 s60, 2, 3
L_rid_n7:
    s_cmp_lg_u32 s27, 6
    s_cbranch_scc1 L_rid_done
    s_cmp_ge_u32 s26, 24
    s_cbranch_scc1 L_rid_done
    s_mov_b32 s60, 1
L_rid_done:
    s_cmp_ge_u32 s28, 4
    s_cbranch_scc1 L_qp
    s_barrier
    buffer_load_dwordx4 v[64:67], v62, s[32:35], s45 offen offset:0 nt
    buffer_load_dwordx4 v[68:71], v62, s[32:35], s45 offen offset:128 nt
    buffer_load_dwordx4 v[72:75], v62, s[32:35], s45 offen offset:256 nt
    buffer_load_dwordx4 v[76:79], v62, s[32:35], s45 offen offset:3072 nt
    buffer_load_dwordx4 v[80:83], v62, s[32:35], s45 offen offset:3200 nt
    buffer_load_dwordx4 v[84:87], v62, s[32:35], s45 offen offset:3328 nt
    buffer_load_dwordx4 v[112:115], v62, s[36:39], s45 offen offset:0 nt
    buffer_load_dwordx4 v[116:119], v62, s[36:39], s45 offen offset:128 nt
    buffer_load_dwordx4 v[120:123], v62, s[36:39], s45 offen offset:256 nt
    buffer_load_dwordx4 v[124:127], v62, s[36:39], s45 offen offset:3072 nt
    buffer_load_dwordx4 v[128:131], v62, s[36:39], s45 offen offset:3200 nt
    buffer_load_dwordx4 v[132:135], v62, s[36:39], s45 offen offset:3328 nt
    s_mul_i32 s62, s28, 36864
    s_add_u32 s62, s62, 16384
    s_waitcnt vmcnt(6)
    buffer_load_dwordx4 v[88:91], v62, s[32:35], s46 offen offset:0 nt
    buffer_load_dwordx4 v[92:95], v62, s[32:35], s46 offen offset:128 nt
    buffer_load_dwordx4 v[96:99], v62, s[32:35], s46 offen offset:256 nt
    buffer_load_dwordx4 v[100:103], v62, s[32:35], s46 offen offset:3072 nt
    buffer_load_dwordx4 v[104:107], v62, s[32:35], s46 offen offset:3200 nt
    buffer_load_dwordx4 v[108:111], v62, s[32:35], s46 offen offset:3328 nt
    s_waitcnt vmcnt(6)
    buffer_load_dwordx4 v[136:139], v62, s[36:39], s46 offen offset:0 nt
    buffer_load_dwordx4 v[140:143], v62, s[36:39], s46 offen offset:128 nt
    buffer_load_dwordx4 v[144:147], v62, s[36:39], s46 offen offset:256 nt
    buffer_load_dwordx4 v[148:151], v62, s[36:39], s46 offen offset:3072 nt
    buffer_load_dwordx4 v[152:155], v62, s[36:39], s46 offen offset:3200 nt
    buffer_load_dwordx4 v[156:159], v62, s[36:39], s46 offen offset:3328 nt
    s_add_u32 s63, s45, 98304
    s_waitcnt vmcnt(6)
    s_add_u32 m0, s62, 0
    s_nop 0
    buffer_load_dwordx4 v62, s[32:35], s63 offen offset:0 nt lds
    s_add_u32 m0, s62, 896
    s_nop 0
    buffer_load_dwordx4 v62, s[32:35], s63 offen offset:128 nt lds
    s_add_u32 m0, s62, 1792
    s_nop 0
    buffer_load_dwordx4 v62, s[32:35], s63 offen offset:256 nt lds
    s_add_u32 m0, s62, 0
    s_nop 0
    buffer_load_dwordx4 v62, s[32:35], s63 offen offset:3072 nt lds
    s_add_u32 m0, s62, 896
    s_nop 0
    buffer_load_dwordx4 v62, s[32:35], s63 offen offset:3200 nt lds
    s_add_u32 m0, s62, 1792
    s_nop 0
    buffer_load_dwordx4 v62, s[32:35], s63 offen offset:3328 nt lds
    s_waitcnt vmcnt(6)
    s_add_u32 m0, s62, 6144
    s_nop 0
    buffer_load_dwordx4 v62, s[36:39], s63 offen offset:0 nt lds
    s_add_u32 m0, s62, 7040
    s_nop 0
    buffer_load_dwordx4 v62, s[36:39], s63 offen offset:128 nt lds
    s_add_u32 m0, s62, 7936
    s_nop 0
    buffer_load_dwordx4 v62, s[36:39], s63 offen offset:256 nt lds
    s_add_u32 m0, s62, 6144
    s_nop 0
    buffer_load_dwordx4 v62, s[36:39], s63 offen offset:3072 nt lds
    s_add_u32 m0, s62, 7040
    s_nop 0
    buffer_load_dwordx4 v62, s[36:39], s63 offen offset:3200 nt lds
    s_add_u32 m0, s62, 7936
    s_nop 0
    buffer_load_dwordx4 v62, s[36:39], s63 offen offset:3328 nt lds
    s_add_u32 s63, s45, 122880
    s_waitcnt vmcnt(6)
    s_add_u32 m0, s62, 12288
    s_nop 0
    buffer_load_dwordx4 v62, s[32:35], s63 offen offset:0 nt lds
    s_add_u32 m0, s62, 13184
    s_nop 0
    buffer_load_dwordx4 v62, s[32:35], s63 offen offset:128 nt lds
    s_add_u32 m0, s62, 14080
    s_nop 0
    buffer_load_dwordx4 v62, s[32:35], s63 offen offset:256 nt lds
    s_add_u32 m0, s62, 12288
    s_nop 0
    buffer_load_dwordx4 v62, s[32:35], s63 offen offset:3072 nt lds
    s_add_u32 m0, s62, 13184
    s_nop 0
    buffer_load_dwordx4 v62, s[32:35], s63 offen offset:3200 nt lds
    s_add_u32 m0, s62, 14080
    s_nop 0
    buffer_load_dwordx4 v62, s[32:35], s63 offen offset:3328 nt lds
    s_waitcnt vmcnt(6)
    s_add_u32 m0, s62, 18432
    s_nop 0
    buffer_load_dwordx4 v62, s[36:39], s63 offen offset:0 nt lds
    s_add_u32 m0, s62, 19328
    s_nop 0
    buffer_load_dwordx4 v62, s[36:39], s63 offen offset:128 nt lds
    s_add_u32 m0, s62, 20224
    s_nop 0
    buffer_load_dwordx4 v62, s[36:39], s63 offen offset:256 nt lds
    s_add_u32 m0, s62, 18432
    s_nop 0
    buffer_load_dwordx4 v62, s[36:39], s63 offen offset:3072 nt lds
    s_add_u32 m0, s62, 19328
    s_nop 0
    buffer_load_dwordx4 v62, s[36:39], s63 offen offset:3200 nt lds
    s_add_u32 m0, s62, 20224
    s_nop 0
    buffer_load_dwordx4 v62, s[36:39], s63 offen offset:3328 nt lds
    s_add_u32 s63, s45, 147456
    s_waitcnt vmcnt(6)
    s_add_u32 m0, s62, 24576
    s_nop 0
    buffer_load_dwordx4 v62, s[32:35], s63 offen offset:0 nt lds
    s_add_u32 m0, s62, 25472
    s_nop 0
    buffer_load_dwordx4 v62, s[32:35], s63 offen offset:128 nt lds
    s_add_u32 m0, s62, 26368
    s_nop 0
    buffer_load_dwordx4 v62, s[32:35], s63 offen offset:256 nt lds
    s_add_u32 m0, s62, 24576
    s_nop 0
    buffer_load_dwordx4 v62, s[32:35], s63 offen offset:3072 nt lds
    s_add_u32 m0, s62, 25472
    s_nop 0
    buffer_load_dwordx4 v62, s[32:35], s63 offen offset:3200 nt lds
    s_add_u32 m0, s62, 26368
    s_nop 0
    buffer_load_dwordx4 v62, s[32:35], s63 offen offset:3328 nt lds
    s_waitcnt vmcnt(6)
    s_add_u32 m0, s62, 30720
    s_nop 0
    buffer_load_dwordx4 v62, s[36:39], s63 offen offset:0 nt lds
    s_add_u32 m0, s62, 31616
    s_nop 0
    buffer_load_dwordx4 v62, s[36:39], s63 offen offset:128 nt lds
    s_add_u32 m0, s62, 32512
    s_nop 0
    buffer_load_dwordx4 v62, s[36:39], s63 offen offset:256 nt lds
    s_add_u32 m0, s62, 30720
    s_nop 0
    buffer_load_dwordx4 v62, s[36:39], s63 offen offset:3072 nt lds
    s_add_u32 m0, s62, 31616
    s_nop 0
    buffer_load_dwordx4 v62, s[36:39], s63 offen offset:3200 nt lds
    s_add_u32 m0, s62, 32512
    s_nop 0
    buffer_load_dwordx4 v62, s[36:39], s63 offen offset:3328 nt lds
    s_branch L_qwait
L_qp:
    s_setprio 0
    s_cmp_eq_u32 s71, 0
    s_cbranch_scc1 L_qp_noprod
    s_cmp_ge_u32 s28, 6
    s_cbranch_scc1 L_nox
    s_sub_u32 s64, s28, 4
    s_mul_i32 s31, s64, 1280
    v_lshlrev_b32 v39, 2, v1
    v_add_u32 v39, s31, v39
    global_load_dword v34, v39, s[4:5] offset:0
    global_load_dword v35, v39, s[4:5] offset:256
    global_load_dword v36, v39, s[4:5] offset:512
    global_load_dword v37, v39, s[4:5] offset:768
    global_load_dword v38, v39, s[4:5] offset:1024
L_nox:
    v_bfe_u32 v51, v0, 3, 5
    s_and_b32 s62, s26, 1
    s_mul_i32 s62, s62, 320
    v_add_u32 v51, s62, v51
    s_mov_b32 s31, 12288
    v_mul_lo_u32 v52, v51, s31
    v_lshl_add_u32 v52, v3, 4, v52
    v_lshlrev_b32 v51, 4, v51
    s_lshl_b32 s31, s70, 7
    s_add_u32 s66, s10, s31
    s_addc_u32 s67, s11, 0
    global_load_dwordx4 v[64:67], v52, s[66:67] nt
    s_add_u32 s66, s66, 393216
    s_addc_u32 s67, s67, 0
    global_load_dwordx4 v[68:71], v52, s[66:67] nt
    s_add_u32 s66, s66, 393216
    s_addc_u32 s67, s67, 0
    global_load_dwordx4 v[72:75], v52, s[66:67] nt
    s_add_u32 s66, s66, 393216
    s_addc_u32 s67, s67, 0
    global_load_dwordx4 v[76:79], v52, s[66:67] nt
    s_add_u32 s66, s66, 393216
    s_addc_u32 s67, s67, 0
    global_load_dwordx4 v[80:83], v52, s[66:67] nt
    s_add_u32 s66, s66, 393216
    s_addc_u32 s67, s67, 0
    global_load_dwordx4 v[84:87], v52, s[66:67] nt
    s_add_u32 s66, s66, 393216
    s_addc_u32 s67, s67, 0
    global_load_dwordx4 v[88:91], v52, s[66:67] nt
    s_add_u32 s66, s66, 393216
    s_addc_u32 s67, s67, 0
    global_load_dwordx4 v[92:95], v52, s[66:67] nt
    s_add_u32 s66, s66, 393216
    s_addc_u32 s67, s67, 0
    global_load_dwordx4 v[96:99], v52, s[66:67] nt
    s_add_u32 s66, s66, 393216
    s_addc_u32 s67, s67, 0
    global_load_dwordx4 v[100:103], v52, s[66:67] nt
    s_barrier
    s_cmp_ge_u32 s28, 6
    s_cbranch_scc1 L_noln1
    s_waitcnt vmcnt(10)
    v_lshlrev_b32 v16, 16, v34
    v_and_b32 v17, 0xffff0000, v34
    v_lshlrev_b32 v18, 16, v35
    v_and_b32 v19, 0xffff0000, v35
    v_lshlrev_b32 v20, 16, v36
    v_and_b32 v21, 0xffff0000, v36
    v_lshlrev_b32 v22, 16, v37
    v_and_b32 v23, 0xffff0000, v37
    v_lshlrev_b32 v24, 16, v38
    v_and_b32 v25, 0xffff0000, v38
    s_lshl_b32 s64, s64, 3
    v_readfirstlane_b32 s31, v16
    s_nop 1
    v_subrev_f32 v28, s31, v16
    v_subrev_f32 v29, s31, v17
    v_add_f32 v27, v28, v29
    v_mul_f32 v26, v28, v28
    v_mul_f32 v31, v29, v29
    v_subrev_f32 v28, s31, v18
    v_subrev_f32 v29, s31, v19
    v_add_f32 v27, v27, v28
    v_fmac_f32 v26, v28, v28
    v_add_f32 v27, v27, v29
    v_fmac_f32 v31, v29, v29
    v_subrev_f32 v28, s31, v20
    v_subrev_f32 v29, s31, v21
    v_add_f32 v27, v27, v28
    v_fmac_f32 v26, v28, v28
    v_add_f32 v27, v27, v29
    v_fmac_f32 v31, v29, v29
    v_subrev_f32 v28, s31, v22
    v_subrev_f32 v29, s31, v23
    v_add_f32 v27, v27, v28
    v_fmac_f32 v26, v28, v28
    v_add_f32 v27, v27, v29
    v_fmac_f32 v31, v29, v29
    v_subrev_f32 v28, s31, v24
    v_subrev_f32 v29, s31, v25
    v_add_f32 v27, v27, v28
    v_fmac_f32 v26, v28, v28
    v_add_f32 v27, v27, v29
    v_fmac_f32 v31, v29, v29
    v_add_f32 v26, v26, v31
    v_add_f32_dpp v27, v27, v27 quad_perm:[1,0,3,2] row_mask:0xf bank_mask:0xf
    s_nop 0
    v_add_f32_dpp v26, v26, v26 quad_perm:[1,0,3,2] row_mask:0xf bank_mask:0xf
    v_add_f32_dpp v27, v27, v27 quad_perm:[2,3,0,1] row_mask:0xf bank_mask:0xf
    s_nop 0
    v_add_f32_dpp v26, v26, v26 quad_perm:[2,3,0,1] row_mask:0xf bank_mask:0xf
    v_add_f32_dpp v27, v27, v27 row_half_mirror row_mask:0xf bank_mask:0xf
    s_nop 0
    v_add_f32_dpp v26, v26, v26 row_half_mirror row_mask:0xf bank_mask:0xf
    v_add_f32_dpp v27, v27, v27 row_mirror row_mask:0xf bank_mask:0xf
    s_nop 0
    v_add_f32_dpp v26, v26, v26 row_mirror row_mask:0xf bank_mask:0xf
    s_nop 1
    v_permlane16_swap_b32 v27, v26
    v_add_f32 v27, v27, v26
    s_nop 0
    v_readlane_b32 s56, v27, 0
    v_readlane_b32 s57, v27, 32
    v_readlane_b32 s58, v27, 16
    v_readlane_b32 s59, v27, 48
    v_mov_b32 v27, s56
    v_mov_b32 v26, s58
    v_add_f32 v27, s57, v27
    v_add_f32 v26, s59, v26
    v_mul_f32 v27, 0x3acccccd, v27
    v_mul_f32 v26, 0x3acccccd, v26
    v_fma_f32 v26, -v27, v27, v26
    v_add_f32 v27, s31, v27
    v_max_f32 v26, 0, v26
    v_cvt_pk_bf16_f32 v28, v26, v27
    v_lshlrev_b32 v26, 16, v28
    v_and_b32 v27, 0xffff0000, v28
    v_add_f32 v26, 0x3727c5ac, v26
    v_cvt_pk_bf16_f32 v28, v26, v26
    v_lshlrev_b32 v26, 16, v28
    v_sqrt_f32 v26, v26
    s_nop 0
    v_cvt_pk_bf16_f32 v28, v26, v26
    v_lshlrev_b32 v26, 16, v28
    v_rcp_f32 v30, v26
    v_lshlrev_b32 v32, 5, v1
    v_add_u32 v32, s64, v32
    v_sub_f32 v16, v16, v27
    v_sub_f32 v17, v17, v27
    v_sub_f32 v18, v18, v27
    v_sub_f32 v19, v19, v27
    v_sub_f32 v20, v20, v27
    v_sub_f32 v21, v21, v27
    v_sub_f32 v22, v22, v27
    v_sub_f32 v23, v23, v27
    v_sub_f32 v24, v24, v27
    v_sub_f32 v25, v25, v27
    v_cvt_pk_bf16_f32 v28, v16, v17
    v_lshlrev_b32 v16, 16, v28
    v_and_b32 v17, 0xffff0000, v28
    v_mul_f32 v28, v16, v30
    v_mul_f32 v29, v17, v30
    v_fma_f32 v16, -v28, v26, v16
    v_fma_f32 v17, -v29, v26, v17
    v_fma_f32 v16, v16, v30, v28
    v_fma_f32 v17, v17, v30, v29
    v_cvt_pk_bf16_f32 v33, v16, v17
    v_and_b32 v16, 0xffff, v33
    v_lshlrev_b32 v17, 16, v33
    ds_write_b64 v32, v[16:17] offset:4096
    v_lshrrev_b32 v28, 16, v33
    v_and_b32 v29, 0xffff0000, v33
    ds_write_b64 v32, v[28:29] offset:4112
    v_cvt_pk_bf16_f32 v28, v18, v19
    v_lshlrev_b32 v18, 16, v28
    v_and_b32 v19, 0xffff0000, v28
    v_mul_f32 v28, v18, v30
    v_mul_f32 v29, v19, v30
    v_fma_f32 v18, -v28, v26, v18
    v_fma_f32 v19, -v29, v26, v19
    v_fma_f32 v18, v18, v30, v28
    v_fma_f32 v19, v19, v30, v29
    v_cvt_pk_bf16_f32 v33, v18, v19
    v_and_b32 v18, 0xffff, v33
    v_lshlrev_b32 v19, 16, v33
    ds_write_b64 v32, v[18:19] offset:6144
    v_lshrrev_b32 v28, 16, v33
    v_and_b32 v29, 0xffff0000, v33
    ds_write_b64 v32, v[28:29] offset:6160
    v_cvt_pk_bf16_f32 v28, v20, v21
    v_lshlrev_b32 v20, 16, v28
    v_and_b32 v21, 0xffff0000, v28
    v_mul_f32 v28, v20, v30
    v_mul_f32 v29, v21, v30
    v_fma_f32 v20, -v28, v26, v20
    v_fma_f32 v21, -v29, v26, v21
    v_fma_f32 v20, v20, v30, v28
    v_fma_f32 v21, v21, v30, v29
    v_cvt_pk_bf16_f32 v33, v20, v21
    v_and_b32 v20, 0xffff, v33
    v_lshlrev_b32 v21, 16, v33
    ds_write_b64 v32, v[20:21] offset:8192
    v_lshrrev_b32 v28, 16, v33
    v_and_b32 v29, 0xffff0000, v33
    ds_write_b64 v32, v[28:29] offset:8208
    v_cvt_pk_bf16_f32 v28, v22, v23
    v_lshlrev_b32 v22, 16, v28
    v_and_b32 v23, 0xffff0000, v28
    v_mul_f32 v28, v22, v30
    v_mul_f32 v29, v23, v30
    v_fma_f32 v22, -v28, v26, v22
    v_fma_f32 v23, -v29, v26, v23
    v_fma_f32 v22, v22, v30, v28
    v_fma_f32 v23, v23, v30, v29
    v_cvt_pk_bf16_f32 v33, v22, v23
    v_and_b32 v22, 0xffff, v33
    v_lshlrev_b32 v23, 16, v33
    ds_write_b64 v32, v[22:23] offset:10240
    v_lshrrev_b32 v28, 16, v33
    v_and_b32 v29, 0xffff0000, v33
    ds_write_b64 v32, v[28:29] offset:10256
    v_cvt_pk_bf16_f32 v28, v24, v25
    v_lshlrev_b32 v24, 16, v28
    v_and_b32 v25, 0xffff0000, v28
    v_mul_f32 v28, v24, v30
    v_mul_f32 v29, v25, v30
    v_fma_f32 v24, -v28, v26, v24
    v_fma_f32 v25, -v29, v26, v25
    v_fma_f32 v24, v24, v30, v28
    v_fma_f32 v25, v25, v30, v29
    v_cvt_pk_bf16_f32 v33, v24, v25
    v_and_b32 v24, 0xffff, v33
    v_lshlrev_b32 v25, 16, v33
    ds_write_b64 v32, v[24:25] offset:12288
    v_lshrrev_b32 v28, 16, v33
    v_and_b32 v29, 0xffff0000, v33
    ds_write_b64 v32, v[28:29] offset:12304
    s_mov_b64 exec, 1
    ds_add_u32 v45, v44 offset:4
    s_mov_b64 exec, -1
L_noln1:
L_ldsw_1:
    ds_read_b32 v53, v45 offset:4
    s_waitcnt lgkmcnt(0)
    v_readfirstlane_b32 s31, v53
    s_nop 0
    s_cmp_lt_u32 s31, 2
    s_cbranch_scc1 L_ldsw_1
    ds_read_b128 v[104:107], v51 offset:4096
    ds_read_b128 v[108:111], v51 offset:4608
    ds_read_b128 v[112:115], v51 offset:5120
    ds_read_b128 v[116:119], v51 offset:5632
    ds_read_b128 v[120:123], v51 offset:6144
    ds_read_b128 v[124:127], v51 offset:6656
    ds_read_b128 v[128:131], v51 offset:7168
    ds_read_b128 v[132:135], v51 offset:7680
    ds_read_b128 v[136:139], v51 offset:8192
    ds_read_b128 v[140:143], v51 offset:8704
    v_mov_b32 v144, 0
    v_mov_b32 v145, 0
    v_mov_b32 v146, 0
    v_mov_b32 v147, 0
    v_mov_b32 v148, 0
    v_mov_b32 v149, 0
    v_mov_b32 v150, 0
    v_mov_b32 v151, 0
    v_mov_b32 v152, 0
    v_mov_b32 v153, 0
    v_mov_b32 v154, 0
    v_mov_b32 v155, 0
    v_mov_b32 v156, 0
    v_mov_b32 v157, 0
    v_mov_b32 v158, 0
    v_mov_b32 v159, 0
    s_waitcnt vmcnt(9) lgkmcnt(9)
    v_dot2c_f32_bf16 v144, v64, v104
    v_dot2c_f32_bf16 v145, v64, v105
    v_dot2c_f32_bf16 v152, v64, v106
    v_dot2c_f32_bf16 v153, v64, v107
    v_dot2c_f32_bf16 v146, v65, v104
    v_dot2c_f32_bf16 v147, v65, v105
    v_dot2c_f32_bf16 v154, v65, v106
    v_dot2c_f32_bf16 v155, v65, v107
    v_dot2c_f32_bf16 v148, v66, v104
    v_dot2c_f32_bf16 v149, v66, v105
    v_dot2c_f32_bf16 v156, v66, v106
    v_dot2c_f32_bf16 v157, v66, v107
    v_dot2c_f32_bf16 v150, v67, v104
    v_dot2c_f32_bf16 v151, v67, v105
    v_dot2c_f32_bf16 v158, v67, v106
    v_dot2c_f32_bf16 v159, v67, v107
    s_waitcnt vmcnt(8) lgkmcnt(8)
    v_dot2c_f32_bf16 v144, v68, v108
    v_dot2c_f32_bf16 v145, v68, v109
    v_dot2c_f32_bf16 v152, v68, v110
    v_dot2c_f32_bf16 v153, v68, v111
    v_dot2c_f32_bf16 v146, v69, v108
    v_dot2c_f32_bf16 v147, v69, v109
    v_dot2c_f32_bf16 v154, v69, v110
    v_dot2c_f32_bf16 v155, v69, v111
    v_dot2c_f32_bf16 v148, v70, v108
    v_dot2c_f32_bf16 v149, v70, v109
    v_dot2c_f32_bf16 v156, v70, v110
    v_dot2c_f32_bf16 v157, v70, v111
    v_dot2c_f32_bf16 v150, v71, v108
    v_dot2c_f32_bf16 v151, v71, v109
    v_dot2c_f32_bf16 v158, v71, v110
    v_dot2c_f32_bf16 v159, v71, v111
    s_waitcnt vmcnt(7) lgkmcnt(7)
    v_dot2c_f32_bf16 v144, v72, v112
    v_dot2c_f32_bf16 v145, v72, v113
    v_dot2c_f32_bf16 v152, v72, v114
    v_dot2c_f32_bf16 v153, v72, v115
    v_dot2c_f32_bf16 v146, v73, v112
    v_dot2c_f32_bf16 v147, v73, v113
    v_dot2c_f32_bf16 v154, v73, v114
    v_dot2c_f32_bf16 v155, v73, v115
    v_dot2c_f32_bf16 v148, v74, v112
    v_dot2c_f32_bf16 v149, v74, v113
    v_dot2c_f32_bf16 v156, v74, v114
    v_dot2c_f32_bf16 v157, v74, v115
    v_dot2c_f32_bf16 v150, v75, v112
    v_dot2c_f32_bf16 v151, v75, v113
    v_dot2c_f32_bf16 v158, v75, v114
    v_dot2c_f32_bf16 v159, v75, v115
    s_waitcnt vmcnt(6) lgkmcnt(6)
    v_dot2c_f32_bf16 v144, v76, v116
    v_dot2c_f32_bf16 v145, v76, v117
    v_dot2c_f32_bf16 v152, v76, v118
    v_dot2c_f32_bf16 v153, v76, v119
    v_dot2c_f32_bf16 v146, v77, v116
    v_dot2c_f32_bf16 v147, v77, v117
    v_dot2c_f32_bf16 v154, v77, v118
    v_dot2c_f32_bf16 v155, v77, v119
    v_dot2c_f32_bf16 v148, v78, v116
    v_dot2c_f32_bf16 v149, v78, v117
    v_dot2c_f32_bf16 v156, v78, v118
    v_dot2c_f32_bf16 v157, v78, v119
    v_dot2c_f32_bf16 v150, v79, v116
    v_dot2c_f32_bf16 v151, v79, v117
    v_dot2c_f32_bf16 v158, v79, v118
    v_dot2c_f32_bf16 v159, v79, v119
    s_waitcnt vmcnt(5) lgkmcnt(5)
    v_dot2c_f32_bf16 v144, v80, v120
    v_dot2c_f32_bf16 v145, v80, v121
    v_dot2c_f32_bf16 v152, v80, v122
    v_dot2c_f32_bf16 v153, v80, v123
    v_dot2c_f32_bf16 v146, v81, v120
    v_dot2c_f32_bf16 v147, v81, v121
    v_dot2c_f32_bf16 v154, v81, v122
    v_dot2c_f32_bf16 v155, v81, v123
    v_dot2c_f32_bf16 v148, v82, v120
    v_dot2c_f32_bf16 v149, v82, v121
    v_dot2c_f32_bf16 v156, v82, v122
    v_dot2c_f32_bf16 v157, v82, v123
    v_dot2c_f32_bf16 v150, v83, v120
    v_dot2c_f32_bf16 v151, v83, v121
    v_dot2c_f32_bf16 v158, v83, v122
    v_dot2c_f32_bf16 v159, v83, v123
    s_waitcnt vmcnt(4) lgkmcnt(4)
    v_dot2c_f32_bf16 v144, v84, v124
    v_dot2c_f32_bf16 v145, v84, v125
    v_dot2c_f32_bf16 v152, v84, v126
    v_dot2c_f32_bf16 v153, v84, v127
    v_dot2c_f32_bf16 v146, v85, v124
    v_dot2c_f32_bf16 v147, v85, v125
    v_dot2c_f32_bf16 v154, v85, v126
    v_dot2c_f32_bf16 v155, v85, v127
    v_dot2c_f32_bf16 v148, v86, v124
    v_dot2c_f32_bf16 v149, v86, v125
    v_dot2c_f32_bf16 v156, v86, v126
    v_dot2c_f32_bf16 v157, v86, v127
    v_dot2c_f32_bf16 v150, v87, v124
    v_dot2c_f32_bf16 v151, v87, v125
    v_dot2c_f32_bf16 v158, v87, v126
    v_dot2c_f32_bf16 v159, v87, v127
    s_waitcnt vmcnt(3) lgkmcnt(3)
    v_dot2c_f32_bf16 v144, v88, v128
    v_dot2c_f32_bf16 v145, v88, v129
    v_dot2c_f32_bf16 v152, v88, v130
    v_dot2c_f32_bf16 v153, v88, v131
    v_dot2c_f32_bf16 v146, v89, v128
    v_dot2c_f32_bf16 v147, v89, v129
    v_dot2c_f32_bf16 v154, v89, v130
    v_dot2c_f32_bf16 v155, v89, v131
    v_dot2c_f32_bf16 v148, v90, v128
    v_dot2c_f32_bf16 v149, v90, v129
    v_dot2c_f32_bf16 v156, v90, v130
    v_dot2c_f32_bf16 v157, v90, v131
    v_dot2c_f32_bf16 v150, v91, v128
    v_dot2c_f32_bf16 v151, v91, v129
    v_dot2c_f32_bf16 v158, v91, v130
    v_dot2c_f32_bf16 v159, v91, v131
    s_waitcnt vmcnt(2) lgkmcnt(2)
    v_dot2c_f32_bf16 v144, v92, v132
    v_dot2c_f32_bf16 v145, v92, v133
    v_dot2c_f32_bf16 v152, v92, v134
    v_dot2c_f32_bf16 v153, v92, v135
    v_dot2c_f32_bf16 v146, v93, v132
    v_dot2c_f32_bf16 v147, v93, v133
    v_dot2c_f32_bf16 v154, v93, v134
    v_dot2c_f32_bf16 v155, v93, v135
    v_dot2c_f32_bf16 v148, v94, v132
    v_dot2c_f32_bf16 v149, v94, v133
    v_dot2c_f32_bf16 v156, v94, v134
    v_dot2c_f32_bf16 v157, v94, v135
    v_dot2c_f32_bf16 v150, v95, v132
    v_dot2c_f32_bf16 v151, v95, v133
    v_dot2c_f32_bf16 v158, v95, v134
    v_dot2c_f32_bf16 v159, v95, v135
    s_waitcnt vmcnt(1) lgkmcnt(1)
    v_dot2c_f32_bf16 v144, v96, v136
    v_dot2c_f32_bf16 v145, v96, v137
    v_dot2c_f32_bf16 v152, v96, v138
    v_dot2c_f32_bf16 v153, v96, v139
    v_dot2c_f32_bf16 v146, v97, v136
    v_dot2c_f32_bf16 v147, v97, v137
    v_dot2c_f32_bf16 v154, v97, v138
    v_dot2c_f32_bf16 v155, v97, v139
    v_dot2c_f32_bf16 v148, v98, v136
    v_dot2c_f32_bf16 v149, v98, v137
    v_dot2c_f32_bf16 v156, v98, v138
    v_dot2c_f32_bf16 v157, v98, v139
    v_dot2c_f32_bf16 v150, v99, v136
    v_dot2c_f32_bf16 v151, v99, v137
    v_dot2c_f32_bf16 v158, v99, v138
    v_dot2c_f32_bf16 v159, v99, v139
    s_waitcnt vmcnt(0) lgkmcnt(0)
    v_dot2c_f32_bf16 v144, v100, v140
    v_dot2c_f32_bf16 v145, v100, v141
    v_dot2c_f32_bf16 v152, v100, v142
    v_dot2c_f32_bf16 v153, v100, v143
    v_dot2c_f32_bf16 v146, v101, v140
    v_dot2c_f32_bf16 v147, v101, v141
    v_dot2c_f32_bf16 v154, v101, v142
    v_dot2c_f32_bf16 v155, v101, v143
    v_dot2c_f32_bf16 v148, v102, v140
    v_dot2c_f32_bf16 v149, v102, v141
    v_dot2c_f32_bf16 v156, v102, v142
    v_dot2c_f32_bf16 v157, v102, v143
    v_dot2c_f32_bf16 v150, v103, v140
    v_dot2c_f32_bf16 v151, v103, v141
    v_dot2c_f32_bf16 v158, v103, v142
    v_dot2c_f32_bf16 v159, v103, v143
    v_permlane16_swap_b32 v144, v152
    v_permlane16_swap_b32 v145, v153
    v_permlane16_swap_b32 v146, v154
    v_permlane16_swap_b32 v147, v155
    v_permlane16_swap_b32 v148, v156
    v_permlane16_swap_b32 v149, v157
    v_permlane16_swap_b32 v150, v158
    v_permlane16_swap_b32 v151, v159
    v_add_f32 v144, v144, v152
    v_add_f32 v145, v145, v153
    v_add_f32 v146, v146, v154
    v_add_f32 v147, v147, v155
    v_add_f32 v148, v148, v156
    v_add_f32 v149, v149, v157
    v_add_f32 v150, v150, v158
    v_add_f32 v151, v151, v159
    v_permlane32_swap_b32 v144, v148
    v_permlane32_swap_b32 v145, v149
    v_permlane32_swap_b32 v146, v150
    v_permlane32_swap_b32 v147, v151
    v_add_f32 v144, v144, v148
    v_add_f32 v145, v145, v149
    v_add_f32 v146, v146, v150
    v_add_f32 v147, v147, v151
    v_add_f32_dpp v144, v144, v144 row_ror:8 row_mask:0xf bank_mask:0xf
    v_add_f32_dpp v145, v145, v145 row_ror:8 row_mask:0xf bank_mask:0xf
    v_add_f32_dpp v146, v146, v146 row_ror:8 row_mask:0xf bank_mask:0xf
    v_add_f32_dpp v147, v147, v147 row_ror:8 row_mask:0xf bank_mask:0xf
    v_lshlrev_b32 v51, 5, v3
    v_bfe_u32 v52, v1, 4, 1
    v_lshl_add_u32 v51, v52, 8, v51
    v_lshrrev_b32 v52, 5, v1
    v_lshl_add_u32 v51, v52, 4, v51
    v_and_b32 v52, 3, v2
    v_lshl_add_u32 v51, v52, 9, v51
    ds_write_b128 v51, v[144:147] offset:512
    s_mov_b64 exec, 1
    ds_add_u32 v45, v44 offset:8
    s_mov_b64 exec, -1
    s_cmp_lg_u32 s28, 7
    s_cbranch_scc1 L_qp_pf
L_ldsw_2:
    ds_read_b32 v53, v45 offset:8
    s_waitcnt lgkmcnt(0)
    v_readfirstlane_b32 s31, v53
    s_nop 0
    s_cmp_lt_u32 s31, 4
    s_cbranch_scc1 L_ldsw_2
    v_lshlrev_b32 v51, 3, v1
    ds_read_b64 v[144:145], v51 offset:512
    ds_read_b64 v[146:147], v51 offset:1024
    ds_read_b64 v[148:149], v51 offset:1536
    ds_read_b64 v[150:151], v51 offset:2048
    s_mul_i32 s30, s30, 0x9E3779B1
    s_add_u32 s30, s30, 0x7F4A7C15
    v_lshrrev_b32 v54, 5, v1
    v_mul_u32_u24 v54, 49152, v54
    v_and_b32 v55, 31, v1
    v_lshl_add_u32 v54, v55, 4, v54
    s_lshl_b32 s31, s70, 9
    s_and_b32 s62, s26, 1
    s_mul_i32 s62, s62, 98304
    s_add_u32 s31, s31, s62
    s_add_u32 s31, s31, 65536
    v_add_u32 v54, s31, v54
    v_mov_b32 v51, s30
    v_mov_b32 v53, s30
    s_waitcnt lgkmcnt(0)
    v_add_f32 v144, v144, v146
    v_add_f32 v145, v145, v147
    v_add_f32 v148, v148, v150
    v_add_f32 v149, v149, v151
    v_add_f32 v50, v144, v148
    v_add_f32 v52, v145, v149
    global_store_dwordx4 v54, v[50:53], s[24:25] sc1
    s_branch L_qpoll
L_qp_noprod:
    s_barrier
    s_cmp_lg_u32 s28, 7
    s_cbranch_scc1 L_qp_pf
    s_waitcnt lgkmcnt(0)
    s_mul_i32 s30, s30, 0x9E3779B1
    s_add_u32 s30, s30, 0x7F4A7C15
L_qpoll:
    s_cmp_lg_u32 s47, 0
    s_cbranch_scc1 L_nocinit
    s_and_b32 s31, s30, 0xfffff000
    v_mov_b32 v50, s31
    s_mov_b64 exec, 1
    global_store_dword v45, v50, s[48:49] sc1
    s_mov_b64 exec, -1
L_nocinit:
    s_lshl_b32 s31, s29, 5
    s_add_u32 s31, s31, s26
    s_mul_i32 s31, s31, 1536
    s_add_u32 s31, s31, 65536
    v_lshlrev_b32 v54, 5, v1
    v_add_u32 v54, s31, v54
    v_add_u32 v55, 98304, v54
    v_cmp_gt_u32 vcc, 48, v1
    s_nop 0
    s_and_saveexec_b64 s[54:55], vcc
    s_mov_b64 s[68:69], exec
    s_mov_b32 s53, 1048576
L_poll_3:
    global_load_dwordx4 v[64:67], v54, s[24:25] offset:0 sc1
    global_load_dwordx4 v[68:71], v54, s[24:25] offset:16 sc1
    global_load_dwordx4 v[72:75], v55, s[24:25] offset:0 sc1
    global_load_dwordx4 v[76:79], v55, s[24:25] offset:16 sc1
    s_waitcnt vmcnt(0)
    v_min_u32 v56, v65, v67
    v_max_u32 v57, v65, v67
    v_min3_u32 v56, v56, v69, v71
    v_max3_u32 v57, v57, v69, v71
    v_min3_u32 v56, v56, v73, v75
    v_max3_u32 v57, v57, v73, v75
    v_min3_u32 v56, v56, v77, v79
    v_max3_u32 v57, v57, v77, v79
    v_xor_b32 v56, s30, v56
    v_xor_b32 v57, s30, v57
    v_or_b32 v56, v56, v57
    v_cmp_ne_u32 vcc, 0, v56
    s_nop 0
    s_and_b64 exec, exec, vcc
    s_cbranch_execz L_polldone_4
    s_sub_u32 s53, s53, 1
    s_cbranch_scc1 L_polldone_4
    s_sleep 1
    s_branch L_poll_3
L_polldone_4:
    s_mov_b64 exec, s[68:69]
    v_add_f32 v64, v64, v72
    v_add_f32 v66, v66, v74
    v_add_f32 v68, v68, v76
    v_add_f32 v70, v70, v78
    v_cvt_pk_bf16_f32 v64, v64, v66
    v_cvt_pk_bf16_f32 v65, v68, v70
    v_lshlrev_b32 v54, 3, v1
    ds_write_b64 v54, v[64:65] offset:64
    s_mov_b64 exec, s[54:55]
    s_waitcnt lgkmcnt(0)
    s_barrier
    buffer_load_dwordx4 v[64:67], v62, s[32:35], s45 offen offset:0 nt
    buffer_load_dwordx4 v[68:71], v62, s[32:35], s45 offen offset:128 nt
    buffer_load_dwordx4 v[72:75], v62, s[32:35], s45 offen offset:256 nt
    buffer_load_dwordx4 v[76:79], v62, s[32:35], s45 offen offset:3072 nt
    buffer_load_dwordx4 v[80:83], v62, s[32:35], s45 offen offset:3200 nt
    buffer_load_dwordx4 v[84:87], v62, s[32:35], s45 offen offset:3328 nt
    buffer_load_dwordx4 v[112:115], v62, s[36:39], s45 offen offset:0 nt
    buffer_load_dwordx4 v[116:119], v62, s[36:39], s45 offen offset:128 nt
    buffer_load_dwordx4 v[120:123], v62, s[36:39], s45 offen offset:256 nt
    buffer_load_dwordx4 v[124:127], v62, s[36:39], s45 offen offset:3072 nt
    buffer_load_dwordx4 v[128:131], v62, s[36:39], s45 offen offset:3200 nt
    buffer_load_dwordx4 v[132:135], v62, s[36:39], s45 offen offset:3328 nt
    buffer_load_dwordx4 v[88:91], v62, s[32:35], s46 offen offset:0 nt
    buffer_load_dwordx4 v[92:95], v62, s[32:35], s46 offen offset:128 nt
    buffer_load_dwordx4 v[96:99], v62, s[32:35], s46 offen offset:256 nt
    buffer_load_dwordx4 v[100:103], v62, s[32:35], s46 offen offset:3072 nt
    buffer_load_dwordx4 v[104:107], v62, s[32:35], s46 offen offset:3200 nt
    buffer_load_dwordx4 v[108:111], v62, s[32:35], s46 offen offset:3328 nt
    buffer_load_dwordx4 v[136:139], v62, s[36:39], s46 offen offset:0 nt
    buffer_load_dwordx4 v[140:143], v62, s[36:39], s46 offen offset:128 nt
    buffer_load_dwordx4 v[144:147], v62, s[36:39], s46 offen offset:256 nt
    buffer_load_dwordx4 v[148:151], v62, s[36:39], s46 offen offset:3072 nt
    buffer_load_dwordx4 v[152:155], v62, s[36:39], s46 offen offset:3200 nt
    buffer_load_dwordx4 v[156:159], v62, s[36:39], s46 offen offset:3328 nt
    s_branch L_qgot
L_qp_pf:
    buffer_load_dwordx4 v[64:67], v62, s[32:35], s45 offen offset:0 nt
    buffer_load_dwordx4 v[68:71], v62, s[32:35], s45 offen offset:128 nt
    buffer_load_dwordx4 v[72:75], v62, s[32:35], s45 offen offset:256 nt
    buffer_load_dwordx4 v[76:79], v62, s[32:35], s45 offen offset:3072 nt
    buffer_load_dwordx4 v[80:83], v62, s[32:35], s45 offen offset:3200 nt
    buffer_load_dwordx4 v[84:87], v62, s[32:35], s45 offen offset:3328 nt
    buffer_load_dwordx4 v[112:115], v62, s[36:39], s45 offen offset:0 nt
    buffer_load_dwordx4 v[116:119], v62, s[36:39], s45 offen offset:128 nt
    buffer_load_dwordx4 v[120:123], v62, s[36:39], s45 offen offset:256 nt
    buffer_load_dwordx4 v[124:127], v62, s[36:39], s45 offen offset:3072 nt
    buffer_load_dwordx4 v[128:131], v62, s[36:39], s45 offen offset:3200 nt
    buffer_load_dwordx4 v[132:135], v62, s[36:39], s45 offen offset:3328 nt
    s_waitcnt vmcnt(6)
    buffer_load_dwordx4 v[88:91], v62, s[32:35], s46 offen offset:0 nt
    buffer_load_dwordx4 v[92:95], v62, s[32:35], s46 offen offset:128 nt
    buffer_load_dwordx4 v[96:99], v62, s[32:35], s46 offen offset:256 nt
    buffer_load_dwordx4 v[100:103], v62, s[32:35], s46 offen offset:3072 nt
    buffer_load_dwordx4 v[104:107], v62, s[32:35], s46 offen offset:3200 nt
    buffer_load_dwordx4 v[108:111], v62, s[32:35], s46 offen offset:3328 nt
    s_waitcnt vmcnt(6)
    buffer_load_dwordx4 v[136:139], v62, s[36:39], s46 offen offset:0 nt
    buffer_load_dwordx4 v[140:143], v62, s[36:39], s46 offen offset:128 nt
    buffer_load_dwordx4 v[144:147], v62, s[36:39], s46 offen offset:256 nt
    buffer_load_dwordx4 v[148:151], v62, s[36:39], s46 offen offset:3072 nt
    buffer_load_dwordx4 v[152:155], v62, s[36:39], s46 offen offset:3200 nt
    buffer_load_dwordx4 v[156:159], v62, s[36:39], s46 offen offset:3328 nt
L_qwait:
    s_waitcnt lgkmcnt(0)
    s_mul_i32 s30, s30, 0x9E3779B1
    s_add_u32 s30, s30, 0x7F4A7C15
    s_barrier
L_qgot:
    s_setprio 0
    v_lshlrev_b32 v50, 4, v3
    ds_read_b128 v[4:7], v50 offset:64
    ds_read_b128 v[8:11], v50 offset:192
    ds_read_b128 v[12:15], v50 offset:320
    v_mov_b32 v16, 0
    v_mov_b32 v17, 0
    v_mov_b32 v18, 0
    v_mov_b32 v19, 0
    v_mov_b32 v20, 0
    v_mov_b32 v21, 0
    v_mov_b32 v22, 0
    v_mov_b32 v23, 0
    v_mov_b32 v24, 0
    v_mov_b32 v25, 0
    v_mov_b32 v26, 0
    v_mov_b32 v27, 0
    v_mov_b32 v28, 0
    v_mov_b32 v29, 0
    v_mov_b32 v30, 0
    v_mov_b32 v31, 0
    v_mov_b32 v32, 0
    v_mov_b32 v33, 0
    v_mov_b32 v34, 0
    v_mov_b32 v35, 0
    v_mov_b32 v36, 0
    v_mov_b32 v37, 0
    v_mov_b32 v38, 0
    v_mov_b32 v39, 0
    v_mov_b32 v40, 0xff800000
    v_mov_b32 v41, 0
    s_waitcnt lgkmcnt(0)
    s_mov_b32 s3, 512
    s_cmp_ge_u32 s28, 4
    s_cselect_b32 s3, 448, s3
    s_mov_b64 exec, 1
    ds_add_rtn_u32 v61, v45, v44 offset:0
    s_mov_b64 exec, -1
    v_mov_b32 v42, 0
    v_mov_b32 v43, 0
    s_waitcnt vmcnt(18)
    v_dot2c_f32_bf16 v42, v64, v4
    v_dot2c_f32_bf16 v43, v76, v4
    v_dot2c_f32_bf16 v42, v65, v5
    v_dot2c_f32_bf16 v43, v77, v5
    v_dot2c_f32_bf16 v42, v66, v6
    v_dot2c_f32_bf16 v43, v78, v6
    v_dot2c_f32_bf16 v42, v67, v7
    v_dot2c_f32_bf16 v43, v79, v7
    v_dot2c_f32_bf16 v42, v68, v8
    v_dot2c_f32_bf16 v43, v80, v8
    v_dot2c_f32_bf16 v42, v69, v9
    v_dot2c_f32_bf16 v43, v81, v9
    v_dot2c_f32_bf16 v42, v70, v10
    v_dot2c_f32_bf16 v43, v82, v10
    v_dot2c_f32_bf16 v42, v71, v11
    v_dot2c_f32_bf16 v43, v83, v11
    v_dot2c_f32_bf16 v42, v72, v12
    v_dot2c_f32_bf16 v43, v84, v12
    v_dot2c_f32_bf16 v42, v73, v13
    v_dot2c_f32_bf16 v43, v85, v13
    v_dot2c_f32_bf16 v42, v74, v14
    v_dot2c_f32_bf16 v43, v86, v14
    v_dot2c_f32_bf16 v42, v75, v15
    v_dot2c_f32_bf16 v43, v87, v15
    s_waitcnt lgkmcnt(0)
    v_readfirstlane_b32 s44, v61
    s_nop 0
    s_cmp_lt_u32 s44, 88
    s_cbranch_scc1 L_priv_5
    s_mov_b32 s50, 1
    s_atomic_add s50, s[48:49], 0 glc
    s_waitcnt lgkmcnt(0)
    s_xor_b32 s31, s50, s30
    s_and_b32 s44, s50, 0xfff
    s_add_u32 s44, s44, 352
    s_lshr_b32 s31, s31, 12
    s_cselect_b32 s44, 4096, s44
    s_not_b32 s50, s30
    s_cmp_ge_u32 s44, s3
    s_cbranch_scc1 L_nreq_7
    s_mov_b32 s50, 1
    s_atomic_add s50, s[48:49], 0 glc
L_nreq_7:
    s_branch L_tkdone_6
L_priv_5:
    s_add_u32 s44, s44, s47
L_tkdone_6:
    s_mul_i32 s45, s44, 6144
    buffer_load_dwordx4 v[64:67], v62, s[32:35], s45 offen offset:0 nt
    buffer_load_dwordx4 v[68:71], v62, s[32:35], s45 offen offset:128 nt
    buffer_load_dwordx4 v[72:75], v62, s[32:35], s45 offen offset:256 nt
    buffer_load_dwordx4 v[76:79], v62, s[32:35], s45 offen offset:3072 nt
    buffer_load_dwordx4 v[80:83], v62, s[32:35], s45 offen offset:3200 nt
    buffer_load_dwordx4 v[84:87], v62, s[32:35], s45 offen offset:3328 nt
    v_add_f32_dpp v42, v42, v42 quad_perm:[1,0,3,2] row_mask:0xf bank_mask:0xf
    v_add_f32_dpp v43, v43, v43 quad_perm:[1,0,3,2] row_mask:0xf bank_mask:0xf
    s_nop 0
    v_add_f32_dpp v42, v42, v42 quad_perm:[2,3,0,1] row_mask:0xf bank_mask:0xf
    v_add_f32_dpp v43, v43, v43 quad_perm:[2,3,0,1] row_mask:0xf bank_mask:0xf
    s_nop 0
    v_add_f32_dpp v42, v42, v42 row_half_mirror row_mask:0xf bank_mask:0xf
    v_add_f32_dpp v43, v43, v43 row_half_mirror row_mask:0xf bank_mask:0xf
    v_cvt_pk_bf16_f32 v50, v42, v43
    v_lshlrev_b32 v42, 16, v50
    v_and_b32 v43, 0xffff0000, v50
    v_mul_f32 v42, s51, v42
    v_mul_f32 v43, s51, v43
    v_cvt_pk_bf16_f32 v50, v42, v43
    v_lshlrev_b32 v42, 16, v50
    v_and_b32 v43, 0xffff0000, v50
    v_max3_f32 v51, v40, v42, v43
    v_sub_f32 v52, v40, v51
    v_mov_b32 v40, v51
    v_mul_f32 v52, s52, v52
    v_sub_f32 v42, v42, v40
    v_sub_f32 v43, v43, v40
    v_mul_f32 v42, s52, v42
    v_mul_f32 v43, s52, v43
    v_exp_f32 v52, v52
    v_exp_f32 v42, v42
    v_exp_f32 v43, v43
    v_mov_b32 v53, v52
    v_mul_f32 v41, v41, v52
    v_add_f32 v41, v41, v42
    v_add_f32 v41, v41, v43
    v_pk_mul_f32 v[16:17], v[16:17], v[52:53]
    v_pk_mul_f32 v[18:19], v[18:19], v[52:53]
    v_pk_mul_f32 v[20:21], v[20:21], v[52:53]
    v_pk_mul_f32 v[22:23], v[22:23], v[52:53]
    v_pk_mul_f32 v[24:25], v[24:25], v[52:53]
    v_pk_mul_f32 v[26:27], v[26:27], v[52:53]
    v_pk_mul_f32 v[28:29], v[28:29], v[52:53]
    v_pk_mul_f32 v[30:31], v[30:31], v[52:53]
    v_pk_mul_f32 v[32:33], v[32:33], v[52:53]
    v_pk_mul_f32 v[34:35], v[34:35], v[52:53]
    v_pk_mul_f32 v[36:37], v[36:37], v[52:53]
    v_pk_mul_f32 v[38:39], v[38:39], v[52:53]
    s_waitcnt vmcnt(18)
    v_lshlrev_b32 v46, 16, v112
    v_and_b32 v47, 0xffff0000, v112
    v_pk_fma_f32 v[16:17], v[46:47], v[42:43], v[16:17] op_sel:[0,0,0] op_sel_hi:[1,0,1]
    v_lshlrev_b32 v48, 16, v113
    v_and_b32 v49, 0xffff0000, v113
    v_pk_fma_f32 v[18:19], v[48:49], v[42:43], v[18:19] op_sel:[0,0,0] op_sel_hi:[1,0,1]
    v_lshlrev_b32 v46, 16, v114
    v_and_b32 v47, 0xffff0000, v114
    v_pk_fma_f32 v[20:21], v[46:47], v[42:43], v[20:21] op_sel:[0,0,0] op_sel_hi:[1,0,1]
    v_lshlrev_b32 v48, 16, v115
    v_and_b32 v49, 0xffff0000, v115
    v_pk_fma_f32 v[22:23], v[48:49], v[42:43], v[22:23] op_sel:[0,0,0] op_sel_hi:[1,0,1]
    v_lshlrev_b32 v46, 16, v116
    v_and_b32 v47, 0xffff0000, v116
    v_pk_fma_f32 v[24:25], v[46:47], v[42:43], v[24:25] op_sel:[0,0,0] op_sel_hi:[1,0,1]
    v_lshlrev_b32 v48, 16, v117
    v_and_b32 v49, 0xffff0000, v117
    v_pk_fma_f32 v[26:27], v[48:49], v[42:43], v[26:27] op_sel:[0,0,0] op_sel_hi:[1,0,1]
    v_lshlrev_b32 v46, 16, v118
    v_and_b32 v47, 0xffff0000, v118
    v_pk_fma_f32 v[28:29], v[46:47], v[42:43], v[28:29] op_sel:[0,0,0] op_sel_hi:[1,0,1]
    v_lshlrev_b32 v48, 16, v119
    v_and_b32 v49, 0xffff0000, v119
    v_pk_fma_f32 v[30:31], v[48:49], v[42:43], v[30:31] op_sel:[0,0,0] op_sel_hi:[1,0,1]
    v_lshlrev_b32 v46, 16, v120
    v_and_b32 v47, 0xffff0000, v120
    v_pk_fma_f32 v[32:33], v[46:47], v[42:43], v[32:33] op_sel:[0,0,0] op_sel_hi:[1,0,1]
    v_lshlrev_b32 v48, 16, v121
    v_and_b32 v49, 0xffff0000, v121
    v_pk_fma_f32 v[34:35], v[48:49], v[42:43], v[34:35] op_sel:[0,0,0] op_sel_hi:[1,0,1]
    v_lshlrev_b32 v46, 16, v122
    v_and_b32 v47, 0xffff0000, v122
    v_pk_fma_f32 v[36:37], v[46:47], v[42:43], v[36:37] op_sel:[0,0,0] op_sel_hi:[1,0,1]
    v_lshlrev_b32 v48, 16, v123
    v_and_b32 v49, 0xffff0000, v123
    v_pk_fma_f32 v[38:39], v[48:49], v[42:43], v[38:39] op_sel:[0,0,0] op_sel_hi:[1,0,1]
    v_lshlrev_b32 v46, 16, v124
    v_and_b32 v47, 0xffff0000, v124
    v_pk_fma_f32 v[16:17], v[46:47], v[42:43], v[16:17] op_sel:[0,1,0] op_sel_hi:[1,1,1]
    v_lshlrev_b32 v48, 16, v125
    v_and_b32 v49, 0xffff0000, v125
    v_pk_fma_f32 v[18:19], v[48:49], v[42:43], v[18:19] op_sel:[0,1,0] op_sel_hi:[1,1,1]
    v_lshlrev_b32 v46, 16, v126
    v_and_b32 v47, 0xffff0000, v126
    v_pk_fma_f32 v[20:21], v[46:47], v[42:43], v[20:21] op_sel:[0,1,0] op_sel_hi:[1,1,1]
    v_lshlrev_b32 v48, 16, v127
    v_and_b32 v49, 0xffff0000, v127
    v_pk_fma_f32 v[22:23], v[48:49], v[42:43], v[22:23] op_sel:[0,1,0] op_sel_hi:[1,1,1]
    v_lshlrev_b32 v46, 16, v128
    v_and_b32 v47, 0xffff0000, v128
    v_pk_fma_f32 v[24:25], v[46:47], v[42:43], v[24:25] op_sel:[0,1,0] op_sel_hi:[1,1,1]
    v_lshlrev_b32 v48, 16, v129
    v_and_b32 v49, 0xffff0000, v129
    v_pk_fma_f32 v[26:27], v[48:49], v[42:43], v[26:27] op_sel:[0,1,0] op_sel_hi:[1,1,1]
    v_lshlrev_b32 v46, 16, v130
    v_and_b32 v47, 0xffff0000, v130
    v_pk_fma_f32 v[28:29], v[46:47], v[42:43], v[28:29] op_sel:[0,1,0] op_sel_hi:[1,1,1]
    v_lshlrev_b32 v48, 16, v131
    v_and_b32 v49, 0xffff0000, v131
    v_pk_fma_f32 v[30:31], v[48:49], v[42:43], v[30:31] op_sel:[0,1,0] op_sel_hi:[1,1,1]
    v_lshlrev_b32 v46, 16, v132
    v_and_b32 v47, 0xffff0000, v132
    v_pk_fma_f32 v[32:33], v[46:47], v[42:43], v[32:33] op_sel:[0,1,0] op_sel_hi:[1,1,1]
    v_lshlrev_b32 v48, 16, v133
    v_and_b32 v49, 0xffff0000, v133
    v_pk_fma_f32 v[34:35], v[48:49], v[42:43], v[34:35] op_sel:[0,1,0] op_sel_hi:[1,1,1]
    v_lshlrev_b32 v46, 16, v134
    v_and_b32 v47, 0xffff0000, v134
    v_pk_fma_f32 v[36:37], v[46:47], v[42:43], v[36:37] op_sel:[0,1,0] op_sel_hi:[1,1,1]
    v_lshlrev_b32 v48, 16, v135
    v_and_b32 v49, 0xffff0000, v135
    v_pk_fma_f32 v[38:39], v[48:49], v[42:43], v[38:39] op_sel:[0,1,0] op_sel_hi:[1,1,1]
    buffer_load_dwordx4 v[112:115], v62, s[36:39], s45 offen offset:0 nt
    buffer_load_dwordx4 v[116:119], v62, s[36:39], s45 offen offset:128 nt
    buffer_load_dwordx4 v[120:123], v62, s[36:39], s45 offen offset:256 nt
    buffer_load_dwordx4 v[124:127], v62, s[36:39], s45 offen offset:3072 nt
    buffer_load_dwordx4 v[128:131], v62, s[36:39], s45 offen offset:3200 nt
    buffer_load_dwordx4 v[132:135], v62, s[36:39], s45 offen offset:3328 nt
    s_cmp_lt_u32 s28, 4
    s_cselect_b32 s64, 3, 0
    s_mul_i32 s62, s28, 36864
    s_add_u32 s62, s62, 16384
    v_lshlrev_b32 v58, 4, v1
    v_add_u32 v58, s62, v58
    s_waitcnt vmcnt(12)
L_bloop:
    v_mov_b32 v42, 0
    v_mov_b32 v43, 0
    v_dot2c_f32_bf16 v42, v88, v4
    v_dot2c_f32_bf16 v43, v100, v4
    v_dot2c_f32_bf16 v42, v89, v5
    v_dot2c_f32_bf16 v43, v101, v5
    v_dot2c_f32_bf16 v42, v90, v6
    v_dot2c_f32_bf16 v43, v102, v6
    v_dot2c_f32_bf16 v42, v91, v7
    v_dot2c_f32_bf16 v43, v103, v7
    v_dot2c_f32_bf16 v42, v92, v8
    v_dot2c_f32_bf16 v43, v104, v8
    v_dot2c_f32_bf16 v42, v93, v9
    v_dot2c_f32_bf16 v43, v105, v9
    v_dot2c_f32_bf16 v42, v94, v10
    v_dot2c_f32_bf16 v43, v106, v10
    v_dot2c_f32_bf16 v42, v95, v11
    v_dot2c_f32_bf16 v43, v107, v11
    v_dot2c_f32_bf16 v42, v96, v12
    v_dot2c_f32_bf16 v43, v108, v12
    v_dot2c_f32_bf16 v42, v97, v13
    v_dot2c_f32_bf16 v43, v109, v13
    v_dot2c_f32_bf16 v42, v98, v14
    v_dot2c_f32_bf16 v43, v110, v14
    v_dot2c_f32_bf16 v42, v99, v15
    v_dot2c_f32_bf16 v43, v111, v15
    s_nop 1
    v_add_f32_dpp v42, v42, v42 quad_perm:[1,0,3,2] row_mask:0xf bank_mask:0xf
    v_add_f32_dpp v43, v43, v43 quad_perm:[1,0,3,2] row_mask:0xf bank_mask:0xf
    s_nop 0
    v_add_f32_dpp v42, v42, v42 quad_perm:[2,3,0,1] row_mask:0xf bank_mask:0xf
    v_add_f32_dpp v43, v43, v43 quad_perm:[2,3,0,1] row_mask:0xf bank_mask:0xf
    s_nop 0
    v_add_f32_dpp v42, v42, v42 row_half_mirror row_mask:0xf bank_mask:0xf
    v_add_f32_dpp v43, v43, v43 row_half_mirror row_mask:0xf bank_mask:0xf
    v_cvt_pk_bf16_f32 v50, v42, v43
    v_lshlrev_b32 v42, 16, v50
    v_and_b32 v43, 0xffff0000, v50
    v_mul_f32 v42, s51, v42
    v_mul_f32 v43, s51, v43
    v_cvt_pk_bf16_f32 v50, v42, v43
    v_lshlrev_b32 v42, 16, v50
    v_and_b32 v43, 0xffff0000, v50
    v_max3_f32 v51, v40, v42, v43
    v_sub_f32 v52, v40, v51
    v_mov_b32 v40, v51
    v_mul_f32 v52, s52, v52
    v_sub_f32 v42, v42, v40
    v_sub_f32 v43, v43, v40
    v_mul_f32 v42, s52, v42
    v_mul_f32 v43, s52, v43
    v_exp_f32 v52, v52
    v_exp_f32 v42, v42
    v_exp_f32 v43, v43
    v_mov_b32 v53, v52
    v_mul_f32 v41, v41, v52
    v_add_f32 v41, v41, v42
    v_add_f32 v41, v41, v43
    v_pk_mul_f32 v[16:17], v[16:17], v[52:53]
    v_pk_mul_f32 v[18:19], v[18:19], v[52:53]
    v_pk_mul_f32 v[20:21], v[20:21], v[52:53]
    v_pk_mul_f32 v[22:23], v[22:23], v[52:53]
    v_pk_mul_f32 v[24:25], v[24:25], v[52:53]
    v_pk_mul_f32 v[26:27], v[26:27], v[52:53]
    v_pk_mul_f32 v[28:29], v[28:29], v[52:53]
    v_pk_mul_f32 v[30:31], v[30:31], v[52:53]
    v_pk_mul_f32 v[32:33], v[32:33], v[52:53]
    v_pk_mul_f32 v[34:35], v[34:35], v[52:53]
    v_pk_mul_f32 v[36:37], v[36:37], v[52:53]
    v_pk_mul_f32 v[38:39], v[38:39], v[52:53]
    v_lshlrev_b32 v46, 16, v136
    v_and_b32 v47, 0xffff0000, v136
    v_pk_fma_f32 v[16:17], v[46:47], v[42:43], v[16:17] op_sel:[0,0,0] op_sel_hi:[1,0,1]
    v_lshlrev_b32 v48, 16, v137
    v_and_b32 v49, 0xffff0000, v137
    v_pk_fma_f32 v[18:19], v[48:49], v[42:43], v[18:19] op_sel:[0,0,0] op_sel_hi:[1,0,1]
    v_lshlrev_b32 v46, 16, v138
    v_and_b32 v47, 0xffff0000, v138
    v_pk_fma_f32 v[20:21], v[46:47], v[42:43], v[20:21] op_sel:[0,0,0] op_sel_hi:[1,0,1]
    v_lshlrev_b32 v48, 16, v139
    v_and_b32 v49, 0xffff0000, v139
    v_pk_fma_f32 v[22:23], v[48:49], v[42:43], v[22:23] op_sel:[0,0,0] op_sel_hi:[1,0,1]
    v_lshlrev_b32 v46, 16, v140
    v_and_b32 v47, 0xffff0000, v140
    v_pk_fma_f32 v[24:25], v[46:47], v[42:43], v[24:25] op_sel:[0,0,0] op_sel_hi:[1,0,1]
    v_lshlrev_b32 v48, 16, v141
    v_and_b32 v49, 0xffff0000, v141
    v_pk_fma_f32 v[26:27], v[48:49], v[42:43], v[26:27] op_sel:[0,0,0] op_sel_hi:[1,0,1]
    v_lshlrev_b32 v46, 16, v142
    v_and_b32 v47, 0xffff0000, v142
    v_pk_fma_f32 v[28:29], v[46:47], v[42:43], v[28:29] op_sel:[0,0,0] op_sel_hi:[1,0,1]
    v_lshlrev_b32 v48, 16, v143
    v_and_b32 v49, 0xffff0000, v143
    v_pk_fma_f32 v[30:31], v[48:49], v[42:43], v[30:31] op_sel:[0,0,0] op_sel_hi:[1,0,1]
    v_lshlrev_b32 v46, 16, v144
    v_and_b32 v47, 0xffff0000, v144
    v_pk_fma_f32 v[32:33], v[46:47], v[42:43], v[32:33] op_sel:[0,0,0] op_sel_hi:[1,0,1]
    v_lshlrev_b32 v48, 16, v145
    v_and_b32 v49, 0xffff0000, v145
    v_pk_fma_f32 v[34:35], v[48:49], v[42:43], v[34:35] op_sel:[0,0,0] op_sel_hi:[1,0,1]
    v_lshlrev_b32 v46, 16, v146
    v_and_b32 v47, 0xffff0000, v146
    v_pk_fma_f32 v[36:37], v[46:47], v[42:43], v[36:37] op_sel:[0,0,0] op_sel_hi:[1,0,1]
    v_lshlrev_b32 v48, 16, v147
    v_and_b32 v49, 0xffff0000, v147
    v_pk_fma_f32 v[38:39], v[48:49], v[42:43], v[38:39] op_sel:[0,0,0] op_sel_hi:[1,0,1]
    v_lshlrev_b32 v46, 16, v148
    v_and_b32 v47, 0xffff0000, v148
    v_pk_fma_f32 v[16:17], v[46:47], v[42:43], v[16:17] op_sel:[0,1,0] op_sel_hi:[1,1,1]
    v_lshlrev_b32 v48, 16, v149
    v_and_b32 v49, 0xffff0000, v149
    v_pk_fma_f32 v[18:19], v[48:49], v[42:43], v[18:19] op_sel:[0,1,0] op_sel_hi:[1,1,1]
    v_lshlrev_b32 v46, 16, v150
    v_and_b32 v47, 0xffff0000, v150
    v_pk_fma_f32 v[20:21], v[46:47], v[42:43], v[20:21] op_sel:[0,1,0] op_sel_hi:[1,1,1]
    v_lshlrev_b32 v48, 16, v151
    v_and_b32 v49, 0xffff0000, v151
    v_pk_fma_f32 v[22:23], v[48:49], v[42:43], v[22:23] op_sel:[0,1,0] op_sel_hi:[1,1,1]
    v_lshlrev_b32 v46, 16, v152
    v_and_b32 v47, 0xffff0000, v152
    v_pk_fma_f32 v[24:25], v[46:47], v[42:43], v[24:25] op_sel:[0,1,0] op_sel_hi:[1,1,1]
    v_lshlrev_b32 v48, 16, v153
    v_and_b32 v49, 0xffff0000, v153
    v_pk_fma_f32 v[26:27], v[48:49], v[42:43], v[26:27] op_sel:[0,1,0] op_sel_hi:[1,1,1]
    v_lshlrev_b32 v46, 16, v154
    v_and_b32 v47, 0xffff0000, v154
    v_pk_fma_f32 v[28:29], v[46:47], v[42:43], v[28:29] op_sel:[0,1,0] op_sel_hi:[1,1,1]
    v_lshlrev_b32 v48, 16, v155
    v_and_b32 v49, 0xffff0000, v155
    v_pk_fma_f32 v[30:31], v[48:49], v[42:43], v[30:31] op_sel:[0,1,0] op_sel_hi:[1,1,1]
    v_lshlrev_b32 v46, 16, v156
    v_and_b32 v47, 0xffff0000, v156
    v_pk_fma_f32 v[32:33], v[46:47], v[42:43], v[32:33] op_sel:[0,1,0] op_sel_hi:[1,1,1]
    v_lshlrev_b32 v48, 16, v157
    v_and_b32 v49, 0xffff0000, v157
    v_pk_fma_f32 v[34:35], v[48:49], v[42:43], v[34:35] op_sel:[0,1,0] op_sel_hi:[1,1,1]
    v_lshlrev_b32 v46, 16, v158
    v_and_b32 v47, 0xffff0000, v158
    v_pk_fma_f32 v[36:37], v[46:47], v[42:43], v[36:37] op_sel:[0,1,0] op_sel_hi:[1,1,1]
    v_lshlrev_b32 v48, 16, v159
    v_and_b32 v49, 0xffff0000, v159
    v_pk_fma_f32 v[38:39], v[48:49], v[42:43], v[38:39] op_sel:[0,1,0] op_sel_hi:[1,1,1]
    s_cmp_eq_u32 s64, 0
    s_cbranch_scc1 L_bdone
    s_sub_u32 s64, s64, 1
    ds_read_b128 v[88:91], v58 offset:0
    ds_read_b128 v[92:95], v58 offset:1024
    ds_read_b128 v[96:99], v58 offset:2048
    ds_read_b128 v[100:103], v58 offset:3072
    ds_read_b128 v[104:107], v58 offset:4096
    ds_read_b128 v[108:111], v58 offset:5120
    ds_read_b128 v[136:139], v58 offset:6144
    ds_read_b128 v[140:143], v58 offset:7168
    ds_read_b128 v[144:147], v58 offset:8192
    ds_read_b128 v[148:151], v58 offset:9216
    ds_read_b128 v[152:155], v58 offset:10240
    ds_read_b128 v[156:159], v58 offset:11264
    v_add_u32 v58, 12288, v58
    s_waitcnt lgkmcnt(0)
    s_branch L_bloop
L_bdone:
    s_mov_b32 s43, 0x00020000
    s_add_u32 s65, s47, 72
    s_cmp_lg_u32 s60, 1
    s_cbranch_scc1 L_loop
    s_cmp_lt_u32 s28, 4
    s_cbranch_scc1 L_h0
    s_add_u32 s65, s47, 32
    s_branch L_loop
L_h0:
    s_mov_b32 s40, s16
    s_mov_b32 s41, s17
    s_mov_b32 s42, 1966080
    v_lshrrev_b32 v50, 3, v1
    v_mul_u32_u24 v51, 3072, v50
    v_and_b32 v50, 2, v50
    v_xor_b32 v50, v3, v50
    v_lshl_add_u32 v52, v50, 4, v51
    v_xor_b32 v50, 4, v50
    v_lshl_add_u32 v53, v50, 4, v51
    s_mul_i32 s31, s28, 491520
    s_lshl_b32 s63, s61, 7
    s_add_u32 s31, s31, s63
    s_mov_b32 m0, s62
    s_nop 0
    buffer_load_dwordx4 v52, s[40:43], s31 offen nt lds
    s_add_u32 s31, s31, 24576
    s_add_u32 m0, m0, 1024
    s_nop 0
    buffer_load_dwordx4 v53, s[40:43], s31 offen nt lds
    s_add_u32 s31, s31, 24576
    s_add_u32 m0, m0, 1024
    s_nop 0
    buffer_load_dwordx4 v52, s[40:43], s31 offen nt lds
    s_add_u32 s31, s31, 24576
    s_add_u32 m0, m0, 1024
    s_nop 0
    buffer_load_dwordx4 v53, s[40:43], s31 offen nt lds
    s_add_u32 s31, s31, 24576
    s_add_u32 m0, m0, 1024
    s_nop 0
    buffer_load_dwordx4 v52, s[40:43], s31 offen nt lds
    s_add_u32 s31, s31, 24576
    s_add_u32 m0, m0, 1024
    s_nop 0
    buffer_load_dwordx4 v53, s[40:43], s31 offen nt lds
    s_add_u32 s31, s31, 24576
    s_add_u32 m0, m0, 1024
    s_nop 0
    buffer_load_dwordx4 v52, s[40:43], s31 offen nt lds
    s_add_u32 s31, s31, 24576
    s_add_u32 m0, m0, 1024
    s_nop 0
    buffer_load_dwordx4 v53, s[40:43], s31 offen nt lds
    s_add_u32 s31, s31, 24576
    s_add_u32 m0, m0, 1024
    s_nop 0
    buffer_load_dwordx4 v52, s[40:43], s31 offen nt lds
    s_add_u32 s31, s31, 24576
    s_add_u32 m0, m0, 1024
    s_nop 0
    buffer_load_dwordx4 v53, s[40:43], s31 offen nt lds
    s_add_u32 s31, s31, 24576
    s_add_u32 m0, m0, 1024
    s_nop 0
    buffer_load_dwordx4 v52, s[40:43], s31 offen nt lds
    s_add_u32 s31, s31, 24576
    s_add_u32 m0, m0, 1024
    s_nop 0
    buffer_load_dwordx4 v53, s[40:43], s31 offen nt lds
    s_add_u32 s31, s31, 24576
    s_add_u32 m0, m0, 1024
    s_nop 0
    buffer_load_dwordx4 v52, s[40:43], s31 offen nt lds
    s_add_u32 s31, s31, 24576
    s_add_u32 m0, m0, 1024
    s_nop 0
    buffer_load_dwordx4 v53, s[40:43], s31 offen nt lds
    s_add_u32 s31, s31, 24576
    s_add_u32 m0, m0, 1024
    s_nop 0
    buffer_load_dwordx4 v52, s[40:43], s31 offen nt lds
    s_add_u32 s31, s31, 24576
    s_add_u32 m0, m0, 1024
    s_nop 0
    buffer_load_dwordx4 v53, s[40:43], s31 offen nt lds
    s_add_u32 s31, s31, 24576
    s_add_u32 m0, m0, 1024
    s_nop 0
    buffer_load_dwordx4 v52, s[40:43], s31 offen nt lds
    s_add_u32 s31, s31, 24576
    s_add_u32 m0, m0, 1024
    s_nop 0
    buffer_load_dwordx4 v53, s[40:43], s31 offen nt lds
    s_add_u32 s31, s31, 24576
    s_add_u32 m0, m0, 1024
    s_nop 0
    buffer_load_dwordx4 v52, s[40:43], s31 offen nt lds
    s_add_u32 s31, s31, 24576
    s_add_u32 m0, m0, 1024
    s_nop 0
    buffer_load_dwordx4 v53, s[40:43], s31 offen nt lds
    s_waitcnt vmcnt(0)
    s_mov_b64 exec, 1
    ds_add_u32 v45, v44 offset:12
    s_mov_b64 exec, -1
L_loop:
    s_cmp_ge_u32 s44, s65
    s_cbranch_scc1 L_roles
    s_cmp_ge_u32 s44, 352
    s_cbranch_scc1 L_loop2
    s_mov_b64 exec, 1
    ds_add_rtn_u32 v61, v45, v44 offset:0
    s_mov_b64 exec, -1
    v_mov_b32 v42, 0
    v_mov_b32 v43, 0
    s_waitcnt vmcnt(6)
    v_dot2c_f32_bf16 v42, v64, v4
    v_dot2c_f32_bf16 v43, v76, v4
    v_dot2c_f32_bf16 v42, v65, v5
    v_dot2c_f32_bf16 v43, v77, v5
    v_dot2c_f32_bf16 v42, v66, v6
    v_dot2c_f32_bf16 v43, v78, v6
    v_dot2c_f32_bf16 v42, v67, v7
    v_dot2c_f32_bf16 v43, v79, v7
    v_dot2c_f32_bf16 v42, v68, v8
    v_dot2c_f32_bf16 v43, v80, v8
    v_dot2c_f32_bf16 v42, v69, v9
    v_dot2c_f32_bf16 v43, v81, v9
    v_dot2c_f32_bf16 v42, v70, v10
    v_dot2c_f32_bf16 v43, v82, v10
    v_dot2c_f32_bf16 v42, v71, v11
    v_dot2c_f32_bf16 v43, v83, v11
    v_dot2c_f32_bf16 v42, v72, v12
    v_dot2c_f32_bf16 v43, v84, v12
    v_dot2c_f32_bf16 v42, v73, v13
    v_dot2c_f32_bf16 v43, v85, v13
    v_dot2c_f32_bf16 v42, v74, v14
    v_dot2c_f32_bf16 v43, v86, v14
    v_dot2c_f32_bf16 v42, v75, v15
    v_dot2c_f32_bf16 v43, v87, v15
    s_waitcnt lgkmcnt(0)
    v_readfirstlane_b32 s44, v61
    s_nop 0
    s_cmp_lt_u32 s44, 88
    s_cbranch_scc1 L_priv_8
    s_mov_b32 s50, 1
    s_atomic_add s50, s[48:49], 0 glc
    s_waitcnt lgkmcnt(0)
    s_xor_b32 s31, s50, s30
    s_and_b32 s44, s50, 0xfff
    s_add_u32 s44, s44, 352
    s_lshr_b32 s31, s31, 12
    s_cselect_b32 s44, 4096, s44
    s_not_b32 s50, s30
    s_cmp_ge_u32 s44, s3
    s_cbranch_scc1 L_nreq_10
    s_mov_b32 s50, 1
    s_atomic_add s50, s[48:49], 0 glc
L_nreq_10:
    s_branch L_tkdone_9
L_priv_8:
    s_add_u32 s44, s44, s47
L_tkdone_9:
    s_mul_i32 s45, s44, 6144
    buffer_load_dwordx4 v[64:67], v62, s[32:35], s45 offen offset:0 nt
    buffer_load_dwordx4 v[68:71], v62, s[32:35], s45 offen offset:128 nt
    buffer_load_dwordx4 v[72:75], v62, s[32:35], s45 offen offset:256 nt
    buffer_load_dwordx4 v[76:79], v62, s[32:35], s45 offen offset:3072 nt
    buffer_load_dwordx4 v[80:83], v62, s[32:35], s45 offen offset:3200 nt
    buffer_load_dwordx4 v[84:87], v62, s[32:35], s45 offen offset:3328 nt
    v_add_f32_dpp v42, v42, v42 quad_perm:[1,0,3,2] row_mask:0xf bank_mask:0xf
    v_add_f32_dpp v43, v43, v43 quad_perm:[1,0,3,2] row_mask:0xf bank_mask:0xf
    s_nop 0
    v_add_f32_dpp v42, v42, v42 quad_perm:[2,3,0,1] row_mask:0xf bank_mask:0xf
    v_add_f32_dpp v43, v43, v43 quad_perm:[2,3,0,1] row_mask:0xf bank_mask:0xf
    s_nop 0
    v_add_f32_dpp v42, v42, v42 row_half_mirror row_mask:0xf bank_mask:0xf
    v_add_f32_dpp v43, v43, v43 row_half_mirror row_mask:0xf bank_mask:0xf
    v_cvt_pk_bf16_f32 v50, v42, v43
    v_lshlrev_b32 v42, 16, v50
    v_and_b32 v43, 0xffff0000, v50
    v_mul_f32 v42, s51, v42
    v_mul_f32 v43, s51, v43
    v_cvt_pk_bf16_f32 v50, v42, v43
    v_lshlrev_b32 v42, 16, v50
    v_and_b32 v43, 0xffff0000, v50
    v_max3_f32 v51, v40, v42, v43
    v_sub_f32 v52, v40, v51
    v_mov_b32 v40, v51
    v_mul_f32 v52, s52, v52
    v_sub_f32 v42, v42, v40
    v_sub_f32 v43, v43, v40
    v_mul_f32 v42, s52, v42
    v_mul_f32 v43, s52, v43
    v_exp_f32 v52, v52
    v_exp_f32 v42, v42
    v_exp_f32 v43, v43
    v_mov_b32 v53, v52
    v_mul_f32 v41, v41, v52
    v_add_f32 v41, v41, v42
    v_add_f32 v41, v41, v43
    v_pk_mul_f32 v[16:17], v[16:17], v[52:53]
    v_pk_mul_f32 v[18:19], v[18:19], v[52:53]
    v_pk_mul_f32 v[20:21], v[20:21], v[52:53]
    v_pk_mul_f32 v[22:23], v[22:23], v[52:53]
    v_pk_mul_f32 v[24:25], v[24:25], v[52:53]
    v_pk_mul_f32 v[26:27], v[26:27], v[52:53]
    v_pk_mul_f32 v[28:29], v[28:29], v[52:53]
    v_pk_mul_f32 v[30:31], v[30:31], v[52:53]
    v_pk_mul_f32 v[32:33], v[32:33], v[52:53]
    v_pk_mul_f32 v[34:35], v[34:35], v[52:53]
    v_pk_mul_f32 v[36:37], v[36:37], v[52:53]
    v_pk_mul_f32 v[38:39], v[38:39], v[52:53]
    s_waitcnt vmcnt(6)
    v_lshlrev_b32 v46, 16, v112
    v_and_b32 v47, 0xffff0000, v112
    v_pk_fma_f32 v[16:17], v[46:47], v[42:43], v[16:17] op_sel:[0,0,0] op_sel_hi:[1,0,1]
    v_lshlrev_b32 v48, 16, v113
    v_and_b32 v49, 0xffff0000, v113
    v_pk_fma_f32 v[18:19], v[48:49], v[42:43], v[18:19] op_sel:[0,0,0] op_sel_hi:[1,0,1]
    v_lshlrev_b32 v46, 16, v114
    v_and_b32 v47, 0xffff0000, v114
    v_pk_fma_f32 v[20:21], v[46:47], v[42:43], v[20:21] op_sel:[0,0,0] op_sel_hi:[1,0,1]
    v_lshlrev_b32 v48, 16, v115
    v_and_b32 v49, 0xffff0000, v115
    v_pk_fma_f32 v[22:23], v[48:49], v[42:43], v[22:23] op_sel:[0,0,0] op_sel_hi:[1,0,1]
    v_lshlrev_b32 v46, 16, v116
    v_and_b32 v47, 0xffff0000, v116
    v_pk_fma_f32 v[24:25], v[46:47], v[42:43], v[24:25] op_sel:[0,0,0] op_sel_hi:[1,0,1]
    v_lshlrev_b32 v48, 16, v117
    v_and_b32 v49, 0xffff0000, v117
    v_pk_fma_f32 v[26:27], v[48:49], v[42:43], v[26:27] op_sel:[0,0,0] op_sel_hi:[1,0,1]
    v_lshlrev_b32 v46, 16, v118
    v_and_b32 v47, 0xffff0000, v118
    v_pk_fma_f32 v[28:29], v[46:47], v[42:43], v[28:29] op_sel:[0,0,0] op_sel_hi:[1,0,1]
    v_lshlrev_b32 v48, 16, v119
    v_and_b32 v49, 0xffff0000, v119
    v_pk_fma_f32 v[30:31], v[48:49], v[42:43], v[30:31] op_sel:[0,0,0] op_sel_hi:[1,0,1]
    v_lshlrev_b32 v46, 16, v120
    v_and_b32 v47, 0xffff0000, v120
    v_pk_fma_f32 v[32:33], v[46:47], v[42:43], v[32:33] op_sel:[0,0,0] op_sel_hi:[1,0,1]
    v_lshlrev_b32 v48, 16, v121
    v_and_b32 v49, 0xffff0000, v121
    v_pk_fma_f32 v[34:35], v[48:49], v[42:43], v[34:35] op_sel:[0,0,0] op_sel_hi:[1,0,1]
    v_lshlrev_b32 v46, 16, v122
    v_and_b32 v47, 0xffff0000, v122
    v_pk_fma_f32 v[36:37], v[46:47], v[42:43], v[36:37] op_sel:[0,0,0] op_sel_hi:[1,0,1]
    v_lshlrev_b32 v48, 16, v123
    v_and_b32 v49, 0xffff0000, v123
    v_pk_fma_f32 v[38:39], v[48:49], v[42:43], v[38:39] op_sel:[0,0,0] op_sel_hi:[1,0,1]
    v_lshlrev_b32 v46, 16, v124
    v_and_b32 v47, 0xffff0000, v124
    v_pk_fma_f32 v[16:17], v[46:47], v[42:43], v[16:17] op_sel:[0,1,0] op_sel_hi:[1,1,1]
    v_lshlrev_b32 v48, 16, v125
    v_and_b32 v49, 0xffff0000, v125
    v_pk_fma_f32 v[18:19], v[48:49], v[42:43], v[18:19] op_sel:[0,1,0] op_sel_hi:[1,1,1]
    v_lshlrev_b32 v46, 16, v126
    v_and_b32 v47, 0xffff0000, v126
    v_pk_fma_f32 v[20:21], v[46:47], v[42:43], v[20:21] op_sel:[0,1,0] op_sel_hi:[1,1,1]
    v_lshlrev_b32 v48, 16, v127
    v_and_b32 v49, 0xffff0000, v127
    v_pk_fma_f32 v[22:23], v[48:49], v[42:43], v[22:23] op_sel:[0,1,0] op_sel_hi:[1,1,1]
    v_lshlrev_b32 v46, 16, v128
    v_and_b32 v47, 0xffff0000, v128
    v_pk_fma_f32 v[24:25], v[46:47], v[42:43], v[24:25] op_sel:[0,1,0] op_sel_hi:[1,1,1]
    v_lshlrev_b32 v48, 16, v129
    v_and_b32 v49, 0xffff0000, v129
    v_pk_fma_f32 v[26:27], v[48:49], v[42:43], v[26:27] op_sel:[0,1,0] op_sel_hi:[1,1,1]
    v_lshlrev_b32 v46, 16, v130
    v_and_b32 v47, 0xffff0000, v130
    v_pk_fma_f32 v[28:29], v[46:47], v[42:43], v[28:29] op_sel:[0,1,0] op_sel_hi:[1,1,1]
    v_lshlrev_b32 v48, 16, v131
    v_and_b32 v49, 0xffff0000, v131
    v_pk_fma_f32 v[30:31], v[48:49], v[42:43], v[30:31] op_sel:[0,1,0] op_sel_hi:[1,1,1]
    v_lshlrev_b32 v46, 16, v132
    v_and_b32 v47, 0xffff0000, v132
    v_pk_fma_f32 v[32:33], v[46:47], v[42:43], v[32:33] op_sel:[0,1,0] op_sel_hi:[1,1,1]
    v_lshlrev_b32 v48, 16, v133
    v_and_b32 v49, 0xffff0000, v133
    v_pk_fma_f32 v[34:35], v[48:49], v[42:43], v[34:35] op_sel:[0,1,0] op_sel_hi:[1,1,1]
    v_lshlrev_b32 v46, 16, v134
    v_and_b32 v47, 0xffff0000, v134
    v_pk_fma_f32 v[36:37], v[46:47], v[42:43], v[36:37] op_sel:[0,1,0] op_sel_hi:[1,1,1]
    v_lshlrev_b32 v48, 16, v135
    v_and_b32 v49, 0xffff0000, v135
    v_pk_fma_f32 v[38:39], v[48:49], v[42:43], v[38:39] op_sel:[0,1,0] op_sel_hi:[1,1,1]
    buffer_load_dwordx4 v[112:115], v62, s[36:39], s45 offen offset:0 nt
    buffer_load_dwordx4 v[116:119], v62, s[36:39], s45 offen offset:128 nt
    buffer_load_dwordx4 v[120:123], v62, s[36:39], s45 offen offset:256 nt
    buffer_load_dwordx4 v[124:127], v62, s[36:39], s45 offen offset:3072 nt
    buffer_load_dwordx4 v[128:131], v62, s[36:39], s45 offen offset:3200 nt
    buffer_load_dwordx4 v[132:135], v62, s[36:39], s45 offen offset:3328 nt
    s_branch L_loop
L_roles:
    s_mov_b32 s65, 0x7fffffff
    s_mul_i32 s62, s28, 36864
    s_add_u32 s62, s62, 16384
    s_cmp_eq_u32 s60, 0
    s_cbranch_scc1 L_role_w
    s_lshl_b32 s63, s61, 1
    s_and_b32 s31, s28, 1
    s_add_u32 s63, s63, s31
    s_min_u32 s63, s63, 39
    s_lshl_b32 s63, s63, 5
    v_bfe_u32 v50, v1, 3, 1
    v_mul_u32_u24 v51, 1280, v50
    v_lshl_add_u32 v51, v3, 2, v51
    v_add_u32 v51, s63, v51
    global_load_dword v63, v51, s[4:5]
    s_cmp_lg_u32 s60, 1
    s_cbranch_scc1 L_loop
    s_cmp_lt_u32 s28, 4
    s_cbranch_scc1 L_h2
L_ldsw_11:
    ds_read_b32 v53, v45 offset:12
    s_waitcnt lgkmcnt(0)
    v_readfirstlane_b32 s31, v53
    s_nop 0
    s_cmp_lt_u32 s31, 4
    s_cbranch_scc1 L_ldsw_11
    v_lshrrev_b32 v54, 4, v1
    v_bfe_u32 v55, v1, 2, 2
    v_lshl_add_u32 v50, v54, 3, v55
    v_lshlrev_b32 v50, 7, v50
    v_and_b32 v51, 1, v54
    v_lshrrev_b32 v52, 1, v55
    v_lshl_or_b32 v51, v51, 1, v52
    v_and_b32 v52, 3, v2
    v_xor_b32 v51, v52, v51
    v_lshl_add_u32 v50, v51, 5, v50
    v_and_b32 v52, 3, v1
    v_lshl_add_u32 v50, v52, 3, v50
    v_add_u32 v50, 16384, v50
    v_add_u32 v51, 36864, v50
    v_add_u32 v52, 73728, v50
    v_add_u32 v53, 110592, v50
    ds_read_b64_tr_b16 v[160:161], v50 offset:0
    ds_read_b64_tr_b16 v[162:163], v50 offset:512
    ds_read_b64_tr_b16 v[164:165], v50 offset:4096
    ds_read_b64_tr_b16 v[166:167], v50 offset:4608
    ds_read_b64_tr_b16 v[168:169], v50 offset:8192
    ds_read_b64_tr_b16 v[170:171], v50 offset:8704
    ds_read_b64_tr_b16 v[172:173], v50 offset:12288
    ds_read_b64_tr_b16 v[174:175], v50 offset:12800
    ds_read_b64_tr_b16 v[176:177], v50 offset:16384
    ds_read_b64_tr_b16 v[178:179], v50 offset:16896
    ds_read_b64_tr_b16 v[180:181], v51 offset:0
    ds_read_b64_tr_b16 v[182:183], v51 offset:512
    ds_read_b64_tr_b16 v[184:185], v51 offset:4096
    ds_read_b64_tr_b16 v[186:187], v51 offset:4608
    ds_read_b64_tr_b16 v[188:189], v51 offset:8192
    ds_read_b64_tr_b16 v[190:191], v51 offset:8704
    ds_read_b64_tr_b16 v[192:193], v51 offset:12288
    ds_read_b64_tr_b16 v[194:195], v51 offset:12800
    ds_read_b64_tr_b16 v[196:197], v51 offset:16384
    ds_read_b64_tr_b16 v[198:199], v51 offset:16896
    ds_read_b64_tr_b16 v[200:201], v52 offset:0
    ds_read_b64_tr_b16 v[202:203], v52 offset:512
    ds_read_b64_tr_b16 v[204:205], v52 offset:4096
    ds_read_b64_tr_b16 v[206:207], v52 offset:4608
    ds_read_b64_tr_b16 v[208:209], v52 offset:8192
    ds_read_b64_tr_b16 v[210:211], v52 offset:8704
    ds_read_b64_tr_b16 v[212:213], v52 offset:12288
    ds_read_b64_tr_b16 v[214:215], v52 offset:12800
    ds_read_b64_tr_b16 v[216:217], v52 offset:16384
    ds_read_b64_tr_b16 v[218:219], v52 offset:16896
    ds_read_b64_tr_b16 v[220:221], v53 offset:0
    ds_read_b64_tr_b16 v[222:223], v53 offset:512
    ds_read_b64_tr_b16 v[224:225], v53 offset:4096
    ds_read_b64_tr_b16 v[226:227], v53 offset:4608
    ds_read_b64_tr_b16 v[228:229], v53 offset:8192
    ds_read_b64_tr_b16 v[230:231], v53 offset:8704
    ds_read_b64_tr_b16 v[232:233], v53 offset:12288
    ds_read_b64_tr_b16 v[234:235], v53 offset:12800
    ds_read_b64_tr_b16 v[236:237], v53 offset:16384
    ds_read_b64_tr_b16 v[238:239], v53 offset:16896
    s_waitcnt lgkmcnt(0)
    s_mov_b64 exec, 1
    ds_add_u32 v45, v44 offset:16
    s_mov_b64 exec, -1
    s_branch L_loop
L_h2:
L_ldsw_12:
    ds_read_b32 v53, v45 offset:16
    s_waitcnt lgkmcnt(0)
    v_readfirstlane_b32 s31, v53
    s_nop 0
    s_cmp_lt_u32 s31, 4
    s_cbranch_scc1 L_ldsw_12
    s_mov_b32 s40, s18
    s_mov_b32 s41, s19
    s_mov_b32 s42, 1966080
    v_lshlrev_b32 v52, 4, v1
    s_lshl_b32 s31, s61, 2
    s_add_u32 s31, s31, s28
    s_mul_i32 s31, s31, 20480
    s_mov_b32 m0, s62
    s_nop 0
    buffer_load_dwordx4 v52, s[40:43], s31 offen nt lds
    s_add_u32 s31, s31, 1024
    s_add_u32 m0, m0, 1024
    s_nop 0
    buffer_load_dwordx4 v52, s[40:43], s31 offen nt lds
    s_add_u32 s31, s31, 1024
    s_add_u32 m0, m0, 1024
    s_nop 0
    buffer_load_dwordx4 v52, s[40:43], s31 offen nt lds
    s_add_u32 s31, s31, 1024
    s_add_u32 m0, m0, 1024
    s_nop 0
    buffer_load_dwordx4 v52, s[40:43], s31 offen nt lds
    s_add_u32 s31, s31, 1024
    s_add_u32 m0, m0, 1024
    s_nop 0
    buffer_load_dwordx4 v52, s[40:43], s31 offen nt lds
    s_add_u32 s31, s31, 1024
    s_add_u32 m0, m0, 1024
    s_nop 0
    buffer_load_dwordx4 v52, s[40:43], s31 offen nt lds
    s_add_u32 s31, s31, 1024
    s_add_u32 m0, m0, 1024
    s_nop 0
    buffer_load_dwordx4 v52, s[40:43], s31 offen nt lds
    s_add_u32 s31, s31, 1024
    s_add_u32 m0, m0, 1024
    s_nop 0
    buffer_load_dwordx4 v52, s[40:43], s31 offen nt lds
    s_add_u32 s31, s31, 1024
    s_add_u32 m0, m0, 1024
    s_nop 0
    buffer_load_dwordx4 v52, s[40:43], s31 offen nt lds
    s_add_u32 s31, s31, 1024
    s_add_u32 m0, m0, 1024
    s_nop 0
    buffer_load_dwordx4 v52, s[40:43], s31 offen nt lds
    s_add_u32 s31, s31, 1024
    s_add_u32 m0, m0, 1024
    s_nop 0
    buffer_load_dwordx4 v52, s[40:43], s31 offen nt lds
    s_add_u32 s31, s31, 1024
    s_add_u32 m0, m0, 1024
    s_nop 0
    buffer_load_dwordx4 v52, s[40:43], s31 offen nt lds
    s_add_u32 s31, s31, 1024
    s_add_u32 m0, m0, 1024
    s_nop 0
    buffer_load_dwordx4 v52, s[40:43], s31 offen nt lds
    s_add_u32 s31, s31, 1024
    s_add_u32 m0, m0, 1024
    s_nop 0
    buffer_load_dwordx4 v52, s[40:43], s31 offen nt lds
    s_add_u32 s31, s31, 1024
    s_add_u32 m0, m0, 1024
    s_nop 0
    buffer_load_dwordx4 v52, s[40:43], s31 offen nt lds
    s_add_u32 s31, s31, 1024
    s_add_u32 m0, m0, 1024
    s_nop 0
    buffer_load_dwordx4 v52, s[40:43], s31 offen nt lds
    s_add_u32 s31, s31, 1024
    s_add_u32 m0, m0, 1024
    s_nop 0
    buffer_load_dwordx4 v52, s[40:43], s31 offen nt lds
    s_add_u32 s31, s31, 1024
    s_add_u32 m0, m0, 1024
    s_nop 0
    buffer_load_dwordx4 v52, s[40:43], s31 offen nt lds
    s_add_u32 s31, s31, 1024
    s_add_u32 m0, m0, 1024
    s_nop 0
    buffer_load_dwordx4 v52, s[40:43], s31 offen nt lds
    s_add_u32 s31, s31, 1024
    s_add_u32 m0, m0, 1024
    s_nop 0
    buffer_load_dwordx4 v52, s[40:43], s31 offen nt lds
    s_branch L_loop
L_role_w:
    s_cmp_ge_u32 s28, 3
    s_cbranch_scc1 L_loop
    s_mov_b32 s40, s12
    s_mov_b32 s41, s13
    s_mov_b32 s42, 7864320
    v_lshrrev_b32 v50, 4, v1
    v_mul_u32_u24 v51, 1280, v50
    v_lshlrev_b32 v50, 1, v50
    v_and_b32 v52, 15, v1
    v_xor_b32 v50, v52, v50
    v_lshl_add_u32 v52, v50, 4, v51
    v_xor_b32 v50, 8, v50
    v_lshl_add_u32 v53, v50, 4, v51
    s_mul_i32 s31, s26, 3
    s_add_u32 s31, s31, s28
    s_mul_i32 s31, s31, 81920
    s_lshl_b32 s63, s27, 8
    s_add_u32 s31, s31, s63
    s_mov_b32 m0, s62
    s_nop 0
    buffer_load_dwordx4 v52, s[40:43], s31 offen nt lds
    s_add_u32 s31, s31, 5120
    s_add_u32 m0, m0, 1024
    s_nop 0
    buffer_load_dwordx4 v52, s[40:43], s31 offen nt lds
    s_add_u32 s31, s31, 5120
    s_add_u32 m0, m0, 1024
    s_nop 0
    buffer_load_dwordx4 v53, s[40:43], s31 offen nt lds
    s_add_u32 s31, s31, 5120
    s_add_u32 m0, m0, 1024
    s_nop 0
    buffer_load_dwordx4 v53, s[40:43], s31 offen nt lds
    s_add_u32 s31, s31, 5120
    s_add_u32 m0, m0, 1024
    s_nop 0
    buffer_load_dwordx4 v52, s[40:43], s31 offen nt lds
    s_add_u32 s31, s31, 5120
    s_add_u32 m0, m0, 1024
    s_nop 0
    buffer_load_dwordx4 v52, s[40:43], s31 offen nt lds
    s_add_u32 s31, s31, 5120
    s_add_u32 m0, m0, 1024
    s_nop 0
    buffer_load_dwordx4 v53, s[40:43], s31 offen nt lds
    s_add_u32 s31, s31, 5120
    s_add_u32 m0, m0, 1024
    s_nop 0
    buffer_load_dwordx4 v53, s[40:43], s31 offen nt lds
    s_add_u32 s31, s31, 5120
    s_add_u32 m0, m0, 1024
    s_nop 0
    buffer_load_dwordx4 v52, s[40:43], s31 offen nt lds
    s_add_u32 s31, s31, 5120
    s_add_u32 m0, m0, 1024
    s_nop 0
    buffer_load_dwordx4 v52, s[40:43], s31 offen nt lds
    s_add_u32 s31, s31, 5120
    s_add_u32 m0, m0, 1024
    s_nop 0
    buffer_load_dwordx4 v53, s[40:43], s31 offen nt lds
    s_add_u32 s31, s31, 5120
    s_add_u32 m0, m0, 1024
    s_nop 0
    buffer_load_dwordx4 v53, s[40:43], s31 offen nt lds
    s_add_u32 s31, s31, 5120
    s_add_u32 m0, m0, 1024
    s_nop 0
    buffer_load_dwordx4 v52, s[40:43], s31 offen nt lds
    s_add_u32 s31, s31, 5120
    s_add_u32 m0, m0, 1024
    s_nop 0
    buffer_load_dwordx4 v52, s[40:43], s31 offen nt lds
    s_add_u32 s31, s31, 5120
    s_add_u32 m0, m0, 1024
    s_nop 0
    buffer_load_dwordx4 v53, s[40:43], s31 offen nt lds
    s_add_u32 s31, s31, 5120
    s_add_u32 m0, m0, 1024
    s_nop 0
    buffer_load_dwordx4 v53, s[40:43], s31 offen nt lds
    s_branch L_loop
L_loop2:
    s_cmp_ge_u32 s44, 512
    s_cbranch_scc1 L_loop_done
    v_mov_b32 v42, 0
    v_mov_b32 v43, 0
    s_waitcnt vmcnt(6)
    v_dot2c_f32_bf16 v42, v64, v4
    v_dot2c_f32_bf16 v43, v76, v4
    v_dot2c_f32_bf16 v42, v65, v5
    v_dot2c_f32_bf16 v43, v77, v5
    v_dot2c_f32_bf16 v42, v66, v6
    v_dot2c_f32_bf16 v43, v78, v6
    v_dot2c_f32_bf16 v42, v67, v7
    v_dot2c_f32_bf16 v43, v79, v7
    v_dot2c_f32_bf16 v42, v68, v8
    v_dot2c_f32_bf16 v43, v80, v8
    v_dot2c_f32_bf16 v42, v69, v9
    v_dot2c_f32_bf16 v43, v81, v9
    v_dot2c_f32_bf16 v42, v70, v10
    v_dot2c_f32_bf16 v43, v82, v10
    v_dot2c_f32_bf16 v42, v71, v11
    v_dot2c_f32_bf16 v43, v83, v11
    v_dot2c_f32_bf16 v42, v72, v12
    v_dot2c_f32_bf16 v43, v84, v12
    v_dot2c_f32_bf16 v42, v73, v13
    v_dot2c_f32_bf16 v43, v85, v13
    v_dot2c_f32_bf16 v42, v74, v14
    v_dot2c_f32_bf16 v43, v86, v14
    v_dot2c_f32_bf16 v42, v75, v15
    v_dot2c_f32_bf16 v43, v87, v15
    s_waitcnt lgkmcnt(0)
    s_xor_b32 s31, s50, s30
    s_and_b32 s44, s50, 0xfff
    s_add_u32 s44, s44, 352
    s_lshr_b32 s31, s31, 12
    s_cselect_b32 s44, 4096, s44
    s_not_b32 s50, s30
    s_cmp_ge_u32 s44, s3
    s_cbranch_scc1 L_nreq_13
    s_mov_b32 s50, 1
    s_atomic_add s50, s[48:49], 0 glc
L_nreq_13:
    s_mul_i32 s45, s44, 6144
    buffer_load_dwordx4 v[64:67], v62, s[32:35], s45 offen offset:0 nt
    buffer_load_dwordx4 v[68:71], v62, s[32:35], s45 offen offset:128 nt
    buffer_load_dwordx4 v[72:75], v62, s[32:35], s45 offen offset:256 nt
    buffer_load_dwordx4 v[76:79], v62, s[32:35], s45 offen offset:3072 nt
    buffer_load_dwordx4 v[80:83], v62, s[32:35], s45 offen offset:3200 nt
    buffer_load_dwordx4 v[84:87], v62, s[32:35], s45 offen offset:3328 nt
    v_add_f32_dpp v42, v42, v42 quad_perm:[1,0,3,2] row_mask:0xf bank_mask:0xf
    v_add_f32_dpp v43, v43, v43 quad_perm:[1,0,3,2] row_mask:0xf bank_mask:0xf
    s_nop 0
    v_add_f32_dpp v42, v42, v42 quad_perm:[2,3,0,1] row_mask:0xf bank_mask:0xf
    v_add_f32_dpp v43, v43, v43 quad_perm:[2,3,0,1] row_mask:0xf bank_mask:0xf
    s_nop 0
    v_add_f32_dpp v42, v42, v42 row_half_mirror row_mask:0xf bank_mask:0xf
    v_add_f32_dpp v43, v43, v43 row_half_mirror row_mask:0xf bank_mask:0xf
    v_cvt_pk_bf16_f32 v50, v42, v43
    v_lshlrev_b32 v42, 16, v50
    v_and_b32 v43, 0xffff0000, v50
    v_mul_f32 v42, s51, v42
    v_mul_f32 v43, s51, v43
    v_cvt_pk_bf16_f32 v50, v42, v43
    v_lshlrev_b32 v42, 16, v50
    v_and_b32 v43, 0xffff0000, v50
    v_max3_f32 v51, v40, v42, v43
    v_sub_f32 v52, v40, v51
    v_mov_b32 v40, v51
    v_mul_f32 v52, s52, v52
    v_sub_f32 v42, v42, v40
    v_sub_f32 v43, v43, v40
    v_mul_f32 v42, s52, v42
    v_mul_f32 v43, s52, v43
    v_exp_f32 v52, v52
    v_exp_f32 v42, v42
    v_exp_f32 v43, v43
    v_mov_b32 v53, v52
    v_mul_f32 v41, v41, v52
    v_add_f32 v41, v41, v42
    v_add_f32 v41, v41, v43
    v_pk_mul_f32 v[16:17], v[16:17], v[52:53]
    v_pk_mul_f32 v[18:19], v[18:19], v[52:53]
    v_pk_mul_f32 v[20:21], v[20:21], v[52:53]
    v_pk_mul_f32 v[22:23], v[22:23], v[52:53]
    v_pk_mul_f32 v[24:25], v[24:25], v[52:53]
    v_pk_mul_f32 v[26:27], v[26:27], v[52:53]
    v_pk_mul_f32 v[28:29], v[28:29], v[52:53]
    v_pk_mul_f32 v[30:31], v[30:31], v[52:53]
    v_pk_mul_f32 v[32:33], v[32:33], v[52:53]
    v_pk_mul_f32 v[34:35], v[34:35], v[52:53]
    v_pk_mul_f32 v[36:37], v[36:37], v[52:53]
    v_pk_mul_f32 v[38:39], v[38:39], v[52:53]
    s_waitcnt vmcnt(6)
    v_lshlrev_b32 v46, 16, v112
    v_and_b32 v47, 0xffff0000, v112
    v_pk_fma_f32 v[16:17], v[46:47], v[42:43], v[16:17] op_sel:[0,0,0] op_sel_hi:[1,0,1]
    v_lshlrev_b32 v48, 16, v113
    v_and_b32 v49, 0xffff0000, v113
    v_pk_fma_f32 v[18:19], v[48:49], v[42:43], v[18:19] op_sel:[0,0,0] op_sel_hi:[1,0,1]
    v_lshlrev_b32 v46, 16, v114
    v_and_b32 v47, 0xffff0000, v114
    v_pk_fma_f32 v[20:21], v[46:47], v[42:43], v[20:21] op_sel:[0,0,0] op_sel_hi:[1,0,1]
    v_lshlrev_b32 v48, 16, v115
    v_and_b32 v49, 0xffff0000, v115
    v_pk_fma_f32 v[22:23], v[48:49], v[42:43], v[22:23] op_sel:[0,0,0] op_sel_hi:[1,0,1]
    v_lshlrev_b32 v46, 16, v116
    v_and_b32 v47, 0xffff0000, v116
    v_pk_fma_f32 v[24:25], v[46:47], v[42:43], v[24:25] op_sel:[0,0,0] op_sel_hi:[1,0,1]
    v_lshlrev_b32 v48, 16, v117
    v_and_b32 v49, 0xffff0000, v117
    v_pk_fma_f32 v[26:27], v[48:49], v[42:43], v[26:27] op_sel:[0,0,0] op_sel_hi:[1,0,1]
    v_lshlrev_b32 v46, 16, v118
    v_and_b32 v47, 0xffff0000, v118
    v_pk_fma_f32 v[28:29], v[46:47], v[42:43], v[28:29] op_sel:[0,0,0] op_sel_hi:[1,0,1]
    v_lshlrev_b32 v48, 16, v119
    v_and_b32 v49, 0xffff0000, v119
    v_pk_fma_f32 v[30:31], v[48:49], v[42:43], v[30:31] op_sel:[0,0,0] op_sel_hi:[1,0,1]
    v_lshlrev_b32 v46, 16, v120
    v_and_b32 v47, 0xffff0000, v120
    v_pk_fma_f32 v[32:33], v[46:47], v[42:43], v[32:33] op_sel:[0,0,0] op_sel_hi:[1,0,1]
    v_lshlrev_b32 v48, 16, v121
    v_and_b32 v49, 0xffff0000, v121
    v_pk_fma_f32 v[34:35], v[48:49], v[42:43], v[34:35] op_sel:[0,0,0] op_sel_hi:[1,0,1]
    v_lshlrev_b32 v46, 16, v122
    v_and_b32 v47, 0xffff0000, v122
    v_pk_fma_f32 v[36:37], v[46:47], v[42:43], v[36:37] op_sel:[0,0,0] op_sel_hi:[1,0,1]
    v_lshlrev_b32 v48, 16, v123
    v_and_b32 v49, 0xffff0000, v123
    v_pk_fma_f32 v[38:39], v[48:49], v[42:43], v[38:39] op_sel:[0,0,0] op_sel_hi:[1,0,1]
    v_lshlrev_b32 v46, 16, v124
    v_and_b32 v47, 0xffff0000, v124
    v_pk_fma_f32 v[16:17], v[46:47], v[42:43], v[16:17] op_sel:[0,1,0] op_sel_hi:[1,1,1]
    v_lshlrev_b32 v48, 16, v125
    v_and_b32 v49, 0xffff0000, v125
    v_pk_fma_f32 v[18:19], v[48:49], v[42:43], v[18:19] op_sel:[0,1,0] op_sel_hi:[1,1,1]
    v_lshlrev_b32 v46, 16, v126
    v_and_b32 v47, 0xffff0000, v126
    v_pk_fma_f32 v[20:21], v[46:47], v[42:43], v[20:21] op_sel:[0,1,0] op_sel_hi:[1,1,1]
    v_lshlrev_b32 v48, 16, v127
    v_and_b32 v49, 0xffff0000, v127
    v_pk_fma_f32 v[22:23], v[48:49], v[42:43], v[22:23] op_sel:[0,1,0] op_sel_hi:[1,1,1]
    v_lshlrev_b32 v46, 16, v128
    v_and_b32 v47, 0xffff0000, v128
    v_pk_fma_f32 v[24:25], v[46:47], v[42:43], v[24:25] op_sel:[0,1,0] op_sel_hi:[1,1,1]
    v_lshlrev_b32 v48, 16, v129
    v_and_b32 v49, 0xffff0000, v129
    v_pk_fma_f32 v[26:27], v[48:49], v[42:43], v[26:27] op_sel:[0,1,0] op_sel_hi:[1,1,1]
    v_lshlrev_b32 v46, 16, v130
    v_and_b32 v47, 0xffff0000, v130
    v_pk_fma_f32 v[28:29], v[46:47], v[42:43], v[28:29] op_sel:[0,1,0] op_sel_hi:[1,1,1]
    v_lshlrev_b32 v48, 16, v131
    v_and_b32 v49, 0xffff0000, v131
    v_pk_fma_f32 v[30:31], v[48:49], v[42:43], v[30:31] op_sel:[0,1,0] op_sel_hi:[1,1,1]
    v_lshlrev_b32 v46, 16, v132
    v_and_b32 v47, 0xffff0000, v132
    v_pk_fma_f32 v[32:33], v[46:47], v[42:43], v[32:33] op_sel:[0,1,0] op_sel_hi:[1,1,1]
    v_lshlrev_b32 v48, 16, v133
    v_and_b32 v49, 0xffff0000, v133
    v_pk_fma_f32 v[34:35], v[48:49], v[42:43], v[34:35] op_sel:[0,1,0] op_sel_hi:[1,1,1]
    v_lshlrev_b32 v46, 16, v134
    v_and_b32 v47, 0xffff0000, v134
    v_pk_fma_f32 v[36:37], v[46:47], v[42:43], v[36:37] op_sel:[0,1,0] op_sel_hi:[1,1,1]
    v_lshlrev_b32 v48, 16, v135
    v_and_b32 v49, 0xffff0000, v135
    v_pk_fma_f32 v[38:39], v[48:49], v[42:43], v[38:39] op_sel:[0,1,0] op_sel_hi:[1,1,1]
    buffer_load_dwordx4 v[112:115], v62, s[36:39], s45 offen offset:0 nt
    buffer_load_dwordx4 v[116:119], v62, s[36:39], s45 offen offset:128 nt
    buffer_load_dwordx4 v[120:123], v62, s[36:39], s45 offen offset:256 nt
    buffer_load_dwordx4 v[124:127], v62, s[36:39], s45 offen offset:3072 nt
    buffer_load_dwordx4 v[128:131], v62, s[36:39], s45 offen offset:3200 nt
    buffer_load_dwordx4 v[132:135], v62, s[36:39], s45 offen offset:3328 nt
    s_branch L_loop2
L_loop_done:
    s_waitcnt vmcnt(0) lgkmcnt(0)
    v_max_f32_dpp v50, v40, v40 row_ror:8 row_mask:0xf bank_mask:0xf
    s_nop 0
    v_readlane_b32 s56, v50, 0
    v_readlane_b32 s57, v50, 16
    v_readlane_b32 s58, v50, 32
    v_readlane_b32 s59, v50, 48
    v_mov_b32 v50, s56
    v_max_f32 v50, s57, v50
    v_max_f32 v50, s58, v50
    v_max_f32 v50, s59, v50
    v_sub_f32 v52, v40, v50
    v_mul_f32 v52, s52, v52
    v_exp_f32 v52, v52
    v_lshlrev_b32 v54, 5, v3
    v_mov_b32 v53, v52
    v_mul_f32 v51, v41, v52
    v_pk_mul_f32 v[16:17], v[16:17], v[52:53]
    v_pk_mul_f32 v[18:19], v[18:19], v[52:53]
    v_pk_mul_f32 v[20:21], v[20:21], v[52:53]
    v_pk_mul_f32 v[22:23], v[22:23], v[52:53]
    v_pk_mul_f32 v[24:25], v[24:25], v[52:53]
    v_pk_mul_f32 v[26:27], v[26:27], v[52:53]
    v_pk_mul_f32 v[28:29], v[28:29], v[52:53]
    v_pk_mul_f32 v[30:31], v[30:31], v[52:53]
    v_pk_mul_f32 v[32:33], v[32:33], v[52:53]
    v_pk_mul_f32 v[34:35], v[34:35], v[52:53]
    v_pk_mul_f32 v[36:37], v[36:37], v[52:53]
    v_pk_mul_f32 v[38:39], v[38:39], v[52:53]
    v_add_f32_dpp v51, v51, v51 row_ror:8 row_mask:0xf bank_mask:0xf
    v_add_f32_dpp v16, v16, v16 row_ror:8 row_mask:0xf bank_mask:0xf
    v_add_f32_dpp v17, v17, v17 row_ror:8 row_mask:0xf bank_mask:0xf
    v_add_f32_dpp v18, v18, v18 row_ror:8 row_mask:0xf bank_mask:0xf
    v_add_f32_dpp v19, v19, v19 row_ror:8 row_mask:0xf bank_mask:0xf
    v_add_f32_dpp v24, v24, v24 row_ror:8 row_mask:0xf bank_mask:0xf
    v_add_f32_dpp v25, v25, v25 row_ror:8 row_mask:0xf bank_mask:0xf
    v_add_f32_dpp v26, v26, v26 row_ror:8 row_mask:0xf bank_mask:0xf
    v_add_f32_dpp v27, v27, v27 row_ror:8 row_mask:0xf bank_mask:0xf
    v_add_f32_dpp v32, v32, v32 row_ror:8 row_mask:0xf bank_mask:0xf
    v_add_f32_dpp v33, v33, v33 row_ror:8 row_mask:0xf bank_mask:0xf
    v_add_f32_dpp v34, v34, v34 row_ror:8 row_mask:0xf bank_mask:0xf
    v_add_f32_dpp v35, v35, v35 row_ror:8 row_mask:0xf bank_mask:0xf
    v_add_f32_dpp v16, v20, v20 row_ror:8 row_mask:0xf bank_mask:0xc
    v_add_f32_dpp v17, v21, v21 row_ror:8 row_mask:0xf bank_mask:0xc
    v_add_f32_dpp v18, v22, v22 row_ror:8 row_mask:0xf bank_mask:0xc
    v_add_f32_dpp v19, v23, v23 row_ror:8 row_mask:0xf bank_mask:0xc
    v_add_f32_dpp v24, v28, v28 row_ror:8 row_mask:0xf bank_mask:0xc
    v_add_f32_dpp v25, v29, v29 row_ror:8 row_mask:0xf bank_mask:0xc
    v_add_f32_dpp v26, v30, v30 row_ror:8 row_mask:0xf bank_mask:0xc
    v_add_f32_dpp v27, v31, v31 row_ror:8 row_mask:0xf bank_mask:0xc
    v_add_f32_dpp v32, v36, v36 row_ror:8 row_mask:0xf bank_mask:0xc
    v_add_f32_dpp v33, v37, v37 row_ror:8 row_mask:0xf bank_mask:0xc
    v_add_f32_dpp v34, v38, v38 row_ror:8 row_mask:0xf bank_mask:0xc
    v_add_f32_dpp v35, v39, v39 row_ror:8 row_mask:0xf bank_mask:0xc
    v_readlane_b32 s56, v51, 0
    v_readlane_b32 s57, v51, 16
    v_readlane_b32 s58, v51, 32
    v_readlane_b32 s59, v51, 48
    v_mov_b32 v51, s56
    v_add_f32 v51, s57, v51
    v_add_f32 v51, s58, v51
    v_add_f32 v51, s59, v51
    v_permlane16_swap_b32 v16, v18
    v_permlane16_swap_b32 v17, v19
    v_permlane16_swap_b32 v24, v26
    v_permlane16_swap_b32 v25, v27
    v_permlane16_swap_b32 v32, v34
    v_permlane16_swap_b32 v33, v35
    v_add_f32 v16, v16, v18
    v_add_f32 v17, v17, v19
    v_add_f32 v24, v24, v26
    v_add_f32 v25, v25, v27
    v_add_f32 v32, v32, v34
    v_add_f32 v33, v33, v35
    v_bfe_u32 v55, v1, 3, 1
    v_lshl_add_u32 v54, v55, 4, v54
    v_permlane32_swap_b32 v16, v17
    v_permlane32_swap_b32 v24, v25
    v_permlane32_swap_b32 v32, v33
    v_bfe_u32 v55, v1, 4, 1
    v_lshl_add_u32 v54, v55, 3, v54
    v_lshrrev_b32 v55, 5, v1
    v_lshl_add_u32 v54, v55, 2, v54
    s_mul_i32 s31, s96, 800
    v_add_u32 v54, s31, v54
    v_lshlrev_b32 v55, 3, v2
    v_add_f32 v16, v16, v17
    v_add_f32 v24, v24, v25
    v_add_f32 v32, v32, v33
    ds_write_b32 v54, v16 offset:5120
    ds_write_b32 v54, v24 offset:5376
    ds_write_b32 v54, v32 offset:5632
    ds_write_b64 v55, v[50:51] offset:11520
    s_waitcnt lgkmcnt(0)
    s_barrier
    s_cmp_ge_u32 s96, 3
    s_cbranch_scc1 L_opub_done
    v_lshlrev_b32 v50, 2, v0
    ds_read_b128 v[72:75], v45 offset:11520
    ds_read_b128 v[76:79], v45 offset:11536
    ds_read_b128 v[80:83], v45 offset:11552
    ds_read_b128 v[84:87], v45 offset:11568
    ds_read_b32 v64, v50 offset:5120
    ds_read_b32 v65, v50 offset:5920
    ds_read_b32 v66, v50 offset:6720
    ds_read_b32 v67, v50 offset:7520
    ds_read_b32 v68, v50 offset:8320
    ds_read_b32 v69, v50 offset:9120
    ds_read_b32 v70, v50 offset:9920
    ds_read_b32 v71, v50 offset:10720
    s_waitcnt lgkmcnt(8)
    v_max_f32 v92, v72, v74
    v_max3_f32 v92, v92, v76, v78
    v_max3_f32 v92, v92, v80, v82
    v_max3_f32 v92, v92, v84, v86
    v_sub_f32 v72, v72, v92
    v_sub_f32 v74, v74, v92
    v_sub_f32 v76, v76, v92
    v_sub_f32 v78, v78, v92
    v_sub_f32 v80, v80, v92
    v_sub_f32 v82, v82, v92
    v_sub_f32 v84, v84, v92
    v_sub_f32 v86, v86, v92
    v_mul_f32 v72, s52, v72
    v_mul_f32 v74, s52, v74
    v_mul_f32 v76, s52, v76
    v_mul_f32 v78, s52, v78
    v_mul_f32 v80, s52, v80
    v_mul_f32 v82, s52, v82
    v_mul_f32 v84, s52, v84
    v_mul_f32 v86, s52, v86
    v_exp_f32 v72, v72
    v_exp_f32 v74, v74
    v_exp_f32 v76, v76
    v_exp_f32 v78, v78
    v_exp_f32 v80, v80
    v_exp_f32 v82, v82
    v_exp_f32 v84, v84
    v_exp_f32 v86, v86
    v_mul_f32 v94, v72, v73
    v_fmac_f32 v94, v74, v75
    v_fmac_f32 v94, v76, v77
    v_fmac_f32 v94, v78, v79
    v_fmac_f32 v94, v80, v81
    v_fmac_f32 v94, v82, v83
    v_fmac_f32 v94, v84, v85
    v_fmac_f32 v94, v86, v87
    v_mov_b32 v89, s30
    v_mov_b32 v93, s30
    v_mov_b32 v95, s30
    s_lshl_b32 s31, s2, 11
    s_add_u32 s31, s31, 262144
    v_lshlrev_b32 v50, 3, v0
    v_add_u32 v50, s31, v50
    s_waitcnt lgkmcnt(0)
    v_mul_f32 v88, v72, v64
    v_fmac_f32 v88, v74, v65
    v_fmac_f32 v88, v76, v66
    v_fmac_f32 v88, v78, v67
    v_fmac_f32 v88, v80, v68
    v_fmac_f32 v88, v82, v69
    v_fmac_f32 v88, v84, v70
    v_fmac_f32 v88, v86, v71
    global_store_dwordx2 v50, v[88:89], s[24:25] sc1
    v_lshl_add_u32 v51, v0, 4, s31
    v_cmp_gt_u32 vcc, 8, v0
    s_nop 0
    s_and_saveexec_b64 s[54:55], vcc
    global_store_dwordx4 v51, v[92:95], s[24:25] offset:1536 sc1
    s_mov_b64 exec, s[54:55]
L_opub_done:
    v_lshrrev_b32 v42, 4, v1
    v_bfe_u32 v43, v1, 2, 2
    v_and_b32 v46, 3, v1
    s_cmp_eq_u32 s60, 0
    s_cbranch_scc1 L_W
    s_cmp_eq_u32 s60, 1
    s_cbranch_scc1 L_F1
    s_cmp_lg_u32 s60, 2
    s_cbranch_scc1 L_end
    s_sub_u32 s31, s96, 2
    s_cmp_lt_u32 s31, 2
    s_cbranch_scc1 L_Runit
    s_branch L_end
L_W:
    v_lshl_add_u32 v50, v42, 3, v43
    v_lshlrev_b32 v50, 8, v50
    v_and_b32 v51, 1, v42
    v_lshl_or_b32 v51, v51, 2, v43
    v_xor_b32 v51, v2, v51
    v_lshl_add_u32 v50, v51, 5, v50
    v_lshl_add_u32 v50, v46, 3, v50
    v_add_u32 v50, 16384, v50
    v_add_u32 v51, 36864, v50
    v_add_u32 v52, 73728, v50
    ds_read_b64_tr_b16 v[100:101], v50 offset:0
    ds_read_b64_tr_b16 v[102:103], v50 offset:1024
    ds_read_b64_tr_b16 v[104:105], v50 offset:8192
    ds_read_b64_tr_b16 v[106:107], v50 offset:9216
    ds_read_b64_tr_b16 v[108:109], v51 offset:0
    ds_read_b64_tr_b16 v[110:111], v51 offset:1024
    ds_read_b64_tr_b16 v[112:113], v51 offset:8192
    ds_read_b64_tr_b16 v[114:115], v51 offset:9216
    ds_read_b64_tr_b16 v[116:117], v52 offset:0
    ds_read_b64_tr_b16 v[118:119], v52 offset:1024
    ds_read_b64_tr_b16 v[120:121], v52 offset:8192
    ds_read_b64_tr_b16 v[122:123], v52 offset:9216
    v_mov_b32 v232, 0
    v_mov_b32 v233, 0
    v_mov_b32 v234, 0
    v_mov_b32 v235, 0
    s_cmp_ge_u32 s96, 6
    s_cbranch_scc1 L_W_gath_done
    s_cmp_ge_u32 s96, 3
    s_cselect_b32 s64, 1, 0
    s_mul_i32 s31, s64, 192
    v_subrev_u32 v54, s31, v0
    s_lshl_b32 s31, s26, 1
    s_add_u32 s31, s31, s64
    s_lshl_b32 s31, s31, 13
    s_add_u32 s31, s31, 266240
    s_add_u32 s66, s24, s31
    s_addc_u32 s67, s25, 0
    v_lshlrev_b32 v55, 3, v54
    s_lshl_b32 s31, s64, 2
    s_xor_b32 s31, s2, s31
    s_xor_b32 s62, s31, 0
    s_lshl_b32 s62, s62, 11
    s_add_u32 s62, s62, 262144
    v_add_u32 v16, s62, v55
    v_mov_b32 v20, s62
    s_xor_b32 s62, s31, 1
    s_lshl_b32 s62, s62, 11
    s_add_u32 s62, s62, 262144
    v_add_u32 v17, s62, v55
    v_mov_b32 v21, s62
    s_xor_b32 s62, s31, 2
    s_lshl_b32 s62, s62, 11
    s_add_u32 s62, s62, 262144
    v_add_u32 v18, s62, v55
    v_mov_b32 v22, s62
    s_xor_b32 s62, s31, 3
    s_lshl_b32 s62, s62, 11
    s_add_u32 s62, s62, 262144
    v_add_u32 v19, s62, v55
    v_mov_b32 v23, s62
    s_cmp_eq_u32 s64, 1
    s_cbranch_scc1 L_W_other
    v_mov_b32 v64, v88
    v_mov_b32 v72, v92
    v_mov_b32 v74, v94
    s_mov_b64 s[68:69], exec
    s_mov_b32 s53, 1048576
L_poll_14:
    global_load_dwordx4 v[76:79], v21, s[24:25] offset:1536 sc1
    global_load_dwordx4 v[80:83], v22, s[24:25] offset:1536 sc1
    global_load_dwordx4 v[84:87], v23, s[24:25] offset:1536 sc1
    global_load_dwordx2 v[66:67], v17, s[24:25] sc1
    global_load_dwordx2 v[68:69], v18, s[24:25] sc1
    global_load_dwordx2 v[70:71], v19, s[24:25] sc1
    s_waitcnt vmcnt(0)
    v_min_u32 v56, v67, v69
    v_max_u32 v57, v67, v69
    v_min3_u32 v56, v56, v71, v77
    v_max3_u32 v57, v57, v71, v77
    v_min3_u32 v56, v56, v81, v85
    v_max3_u32 v57, v57, v81, v85
    v_min3_u32 v56, v56, v79, v83
    v_max3_u32 v57, v57, v79, v83
    v_min_u32 v56, v56, v87
    v_max_u32 v57, v57, v87
    v_xor_b32 v56, s30, v56
    v_xor_b32 v57, s30, v57
    v_or_b32 v56, v56, v57
    v_cmp_ne_u32 vcc, 0, v56
    s_nop 0
    s_and_b64 exec, exec, vcc
    s_cbranch_execz L_polldone_15
    s_sub_u32 s53, s53, 1
    s_cbranch_scc1 L_polldone_15
    s_sleep 1
    s_branch L_poll_14
L_polldone_15:
    s_mov_b64 exec, s[68:69]
    s_branch L_W_got
L_W_other:
    s_mov_b64 s[68:69], exec
    s_mov_b32 s53, 1048576
L_poll_16:
    global_load_dwordx4 v[72:75], v20, s[24:25] offset:1536 sc1
    global_load_dwordx4 v[76:79], v21, s[24:25] offset:1536 sc1
    global_load_dwordx4 v[80:83], v22, s[24:25] offset:1536 sc1
    global_load_dwordx4 v[84:87], v23, s[24:25] offset:1536 sc1
    global_load_dwordx2 v[64:65], v16, s[24:25] sc1
    global_load_dwordx2 v[66:67], v17, s[24:25] sc1
    global_load_dwordx2 v[68:69], v18, s[24:25] sc1
    global_load_dwordx2 v[70:71], v19, s[24:25] sc1
    s_waitcnt vmcnt(0)
    v_min_u32 v56, v65, v67
    v_max_u32 v57, v65, v67
    v_min3_u32 v56, v56, v69, v71
    v_max3_u32 v57, v57, v69, v71
    v_min3_u32 v56, v56, v73, v77
    v_max3_u32 v57, v57, v73, v77
    v_min3_u32 v56, v56, v81, v85
    v_max3_u32 v57, v57, v81, v85
    v_min3_u32 v56, v56, v75, v79
    v_max3_u32 v57, v57, v75, v79
    v_min3_u32 v56, v56, v83, v87
    v_max3_u32 v57, v57, v83, v87
    v_xor_b32 v56, s30, v56
    v_xor_b32 v57, s30, v57
    v_or_b32 v56, v56, v57
    v_cmp_ne_u32 vcc, 0, v56
    s_nop 0
    s_and_b64 exec, exec, vcc
    s_cbranch_execz L_polldone_17
    s_sub_u32 s53, s53, 1
    s_cbranch_scc1 L_polldone_17
    s_sleep 1
    s_branch L_poll_16
L_polldone_17:
    s_mov_b64 exec, s[68:69]
L_W_got:
    v_max_f32 v89, v72, v76
    v_max3_f32 v89, v89, v80, v84
    v_sub_f32 v72, v72, v89
    v_sub_f32 v76, v76, v89
    v_sub_f32 v80, v80, v89
    v_sub_f32 v84, v84, v89
    v_mul_f32 v72, s52, v72
    v_mul_f32 v76, s52, v76
    v_mul_f32 v80, s52, v80
    v_mul_f32 v84, s52, v84
    v_exp_f32 v72, v72
    v_exp_f32 v76, v76
    v_exp_f32 v80, v80
    v_exp_f32 v84, v84
    v_mul_f32 v90, v72, v74
    v_fmac_f32 v90, v76, v78
    v_fmac_f32 v90, v80, v82
    v_fmac_f32 v90, v84, v86
    v_mul_f32 v88, v72, v64
    v_fmac_f32 v88, v76, v66
    v_fmac_f32 v88, v80, v68
    v_fmac_f32 v88, v84, v70
    s_xor_b32 s64, s64, s29
    v_rcp_f32 v91, v90
    s_mul_i32 s31, s64, 384
    v_lshlrev_b32 v55, 1, v54
    v_add_u32 v55, s31, v55
    v_mul_f32 v92, v88, v91
    v_fma_f32 v93, -v92, v90, v88
    v_fma_f32 v92, v93, v91, v92
    v_cvt_pk_bf16_f32 v94, v92, v92
    ds_write_b16 v55, v94 offset:2560
L_W_gath_done:
    v_and_b32 v50, 1, v1
    v_mul_u32_u24 v50, 384, v50
    v_lshl_add_u32 v50, v42, 4, v50
    s_mul_i32 s31, s26, 10240
    s_lshl_b32 s62, s27, 10
    s_add_u32 s31, s31, s62
    s_lshl_b32 s62, s96, 7
    s_add_u32 s31, s31, s62
    s_add_u32 s31, s31, 2097152
    v_lshlrev_b32 v52, 3, v1
    v_add_u32 v52, s31, v52
    v_add_u32 v53, 5120, v52
    s_waitcnt lgkmcnt(0)
    s_barrier
    ds_read_b128 v[180:183], v50 offset:2560
    ds_read_b128 v[184:187], v50 offset:2624
    ds_read_b128 v[188:191], v50 offset:2688
    ds_read_b128 v[192:195], v50 offset:2752
    ds_read_b128 v[196:199], v50 offset:2816
    ds_read_b128 v[200:203], v50 offset:2880
    s_waitcnt lgkmcnt(5)
    v_mfma_f32_16x16x32_bf16 v[232:235], v[180:183], v[100:103], v[232:235]
    s_waitcnt lgkmcnt(4)
    v_mfma_f32_16x16x32_bf16 v[232:235], v[184:187], v[104:107], v[232:235]
    s_waitcnt lgkmcnt(3)
    v_mfma_f32_16x16x32_bf16 v[232:235], v[188:191], v[108:111], v[232:235]
    s_waitcnt lgkmcnt(2)
    v_mfma_f32_16x16x32_bf16 v[232:235], v[192:195], v[112:115], v[232:235]
    s_waitcnt lgkmcnt(1)
    v_mfma_f32_16x16x32_bf16 v[232:235], v[196:199], v[116:119], v[232:235]
    s_waitcnt lgkmcnt(0)
    v_mfma_f32_16x16x32_bf16 v[232:235], v[200:203], v[120:123], v[232:235]
    v_mov_b32 v55, s30
    v_mov_b32 v57, s30
    s_and_b64 exec, s[14:15], 0xffff
    s_nop 4
    v_mov_b32 v54, v232
    v_mov_b32 v56, v233
    global_store_dwordx2 v52, v[54:55], s[24:25] sc1
    global_store_dwordx2 v53, v[56:57], s[24:25] sc1
    s_branch L_end
L_F1:
    v_lshrrev_b32 v50, 1, v42
    v_mul_u32_u24 v50, 36864, v50
    v_and_b32 v51, 1, v42
    v_lshl_add_u32 v52, v51, 3, v43
    v_mul_u32_u24 v52, 1280, v52
    v_add_u32 v50, v50, v52
    v_lshl_add_u32 v50, v46, 3, v50
    s_mul_i32 s31, s96, 160
    s_add_u32 s31, s31, 16384
    v_add_u32 v50, s31, v50
    v_add_u32 v51, 73728, v50
    ds_read_b64_tr_b16 v[112:113], v50 offset:0
    ds_read_b64_tr_b16 v[114:115], v50 offset:5120
    ds_read_b64_tr_b16 v[116:117], v51 offset:0
    ds_read_b64_tr_b16 v[118:119], v51 offset:5120
    ds_read_b64_tr_b16 v[120:121], v50 offset:32
    ds_read_b64_tr_b16 v[122:123], v50 offset:5152
    ds_read_b64_tr_b16 v[124:125], v51 offset:32
    ds_read_b64_tr_b16 v[126:127], v51 offset:5152
    ds_read_b64_tr_b16 v[128:129], v50 offset:64
    ds_read_b64_tr_b16 v[130:131], v50 offset:5184
    ds_read_b64_tr_b16 v[132:133], v51 offset:64
    ds_read_b64_tr_b16 v[134:135], v51 offset:5184
    ds_read_b64_tr_b16 v[136:137], v50 offset:96
    ds_read_b64_tr_b16 v[138:139], v50 offset:5216
    ds_read_b64_tr_b16 v[140:141], v51 offset:96
    ds_read_b64_tr_b16 v[142:143], v51 offset:5216
    ds_read_b64_tr_b16 v[144:145], v50 offset:128
    ds_read_b64_tr_b16 v[146:147], v50 offset:5248
    ds_read_b64_tr_b16 v[148:149], v51 offset:128
    ds_read_b64_tr_b16 v[150:151], v51 offset:5248
    s_cmp_lt_u32 s96, 2
    s_cbranch_scc1 L_F1_ln
    s_cmp_ge_u32 s96, 4
    s_cbranch_scc1 L_F1_ln_done
    s_cmp_ge_u32 s61, 0
    s_cbranch_scc1 L_F1_ln_done
L_Runit:
    s_lshl_b32 s62, s61, 1
    s_and_b32 s31, s96, 1
    s_add_u32 s62, s62, s31
    s_lshl_b32 s62, s62, 7
    v_lshrrev_b32 v51, 3, v1
    v_mul_u32_u24 v51, 5120, v51
    v_lshl_add_u32 v51, v3, 4, v51
    s_add_u32 s63, s62, 2097152
    v_add_u32 v96, s63, v51
    v_add_u32 v97, 40960, v96
    v_add_u32 v98, 81920, v96
    v_add_u32 v99, 122880, v96
    v_add_u32 v100, 163840, v96
    v_add_u32 v101, 204800, v96
    v_add_u32 v102, 245760, v96
    v_add_u32 v103, 286720, v96
    s_add_u32 s62, s62, 3145728
    v_and_b32 v53, 15, v1
    v_lshlrev_b32 v53, 3, v53
    v_lshl_add_u32 v54, v42, 13, v53
    v_add_u32 v54, s62, v54
    s_mov_b64 s[68:69], exec
    s_mov_b32 s53, 1048576
L_poll_18:
    global_load_dwordx4 v[64:67], v96, s[24:25] sc1
    global_load_dwordx4 v[68:71], v97, s[24:25] sc1
    global_load_dwordx4 v[72:75], v98, s[24:25] sc1
    global_load_dwordx4 v[76:79], v99, s[24:25] sc1
    global_load_dwordx4 v[80:83], v100, s[24:25] sc1
    global_load_dwordx4 v[84:87], v101, s[24:25] sc1
    global_load_dwordx4 v[88:91], v102, s[24:25] sc1
    global_load_dwordx4 v[92:95], v103, s[24:25] sc1
    s_waitcnt vmcnt(0)
    v_min_u32 v56, v65, v67
    v_max_u32 v57, v65, v67
    v_min3_u32 v56, v56, v69, v71
    v_max3_u32 v57, v57, v69, v71
    v_min3_u32 v56, v56, v73, v75
    v_max3_u32 v57, v57, v73, v75
    v_min3_u32 v56, v56, v77, v79
    v_max3_u32 v57, v57, v77, v79
    v_min3_u32 v56, v56, v81, v83
    v_max3_u32 v57, v57, v81, v83
    v_min3_u32 v56, v56, v85, v87
    v_max3_u32 v57, v57, v85, v87
    v_min3_u32 v56, v56, v89, v91
    v_max3_u32 v57, v57, v89, v91
    v_min3_u32 v56, v56, v93, v95
    v_max3_u32 v57, v57, v93, v95
    v_xor_b32 v56, s30, v56
    v_xor_b32 v57, s30, v57
    v_or_b32 v56, v56, v57
    v_cmp_ne_u32 vcc, 0, v56
    s_nop 0
    s_and_b64 exec, exec, vcc
    s_cbranch_execz L_polldone_19
    s_sub_u32 s53, s53, 1
    s_cbranch_scc1 L_polldone_19
    s_sleep 1
    s_branch L_poll_18
L_polldone_19:
    s_mov_b64 exec, s[68:69]
    v_add_f32 v64, v64, v68
    v_add_f32 v66, v66, v70
    v_add_f32 v72, v72, v76
    v_add_f32 v74, v74, v78
    v_add_f32 v80, v80, v84
    v_add_f32 v82, v82, v86
    v_add_f32 v88, v88, v92
    v_add_f32 v90, v90, v94
    v_add_f32 v64, v64, v72
    v_add_f32 v66, v66, v74
    v_add_f32 v80, v80, v88
    v_add_f32 v82, v82, v90
    v_add_f32 v64, v64, v80
    v_add_f32 v66, v66, v82
    v_mov_b32 v65, v64
    v_mov_b32 v67, v66
    s_nop 0
    v_permlane16_swap_b32 v64, v65
    v_permlane16_swap_b32 v66, v67
    v_add_f32 v64, v64, v65
    v_add_f32 v66, v66, v67
    v_mov_b32 v65, v64
    v_mov_b32 v67, v66
    s_nop 0
    v_permlane32_swap_b32 v64, v65
    v_permlane32_swap_b32 v66, v67
    v_add_f32 v64, v64, v65
    v_add_f32 v66, v66, v67
    v_cvt_pk_bf16_f32 v68, v64, v66
    v_lshlrev_b32 v64, 16, v68
    v_and_b32 v65, 0xffff0000, v68
    v_lshlrev_b32 v66, 16, v63
    v_and_b32 v67, 0xffff0000, v63
    v_add_f32 v64, v64, v66
    v_add_f32 v65, v65, v67
    v_cvt_pk_bf16_f32 v68, v64, v65
    v_mov_b32 v69, s30
    global_store_dwordx2 v54, v[68:69], s[24:25] sc1
    v_mov_b32 v63, v68
    s_sub_u32 s31, s96, 2
    s_branch L_Eunit
    s_branch L_F1_ln_done
L_F1_ln:
    s_lshl_b32 s31, s96, 6
    s_add_u32 s31, s31, 3147776
    s_and_b32 s62, s61, 3
    s_lshl_b32 s62, s62, 13
    s_add_u32 s31, s31, s62
    v_lshrrev_b32 v50, 3, v1
    v_lshlrev_b32 v50, 7, v50
    v_lshl_add_u32 v50, v3, 3, v50
    v_add_u32 v50, s31, v50
    s_mov_b64 s[68:69], exec
    s_mov_b32 s53, 1048576
L_poll_20:
    global_load_dwordx2 v[64:65], v50, s[24:25] offset:-2048 sc1
    global_load_dwordx2 v[66:67], v50, s[24:25] offset:-1024 sc1
    global_load_dwordx2 v[68:69], v50, s[24:25] offset:0 sc1
    global_load_dwordx2 v[70:71], v50, s[24:25] offset:1024 sc1
    global_load_dwordx2 v[72:73], v50, s[24:25] offset:2048 sc1
    s_waitcnt vmcnt(0)
    v_min_u32 v52, v65, v67
    v_max_u32 v53, v65, v67
    v_min3_u32 v52, v52, v69, v71
    v_max3_u32 v53, v53, v69, v71
    v_min_u32 v52, v52, v73
    v_max_u32 v53, v53, v73
    v_xor_b32 v52, s30, v52
    v_xor_b32 v53, s30, v53
    v_or_b32 v52, v52, v53
    v_cmp_ne_u32 vcc, 0, v52
    s_nop 0
    s_and_b64 exec, exec, vcc
    s_cbranch_execz L_polldone_21
    s_sub_u32 s53, s53, 1
    s_cbranch_scc1 L_polldone_21
    s_sleep 1
    s_branch L_poll_20
L_polldone_21:
    s_mov_b64 exec, s[68:69]
    v_lshlrev_b32 v16, 16, v64
    v_and_b32 v17, 0xffff0000, v64
    v_lshlrev_b32 v18, 16, v66
    v_and_b32 v19, 0xffff0000, v66
    v_lshlrev_b32 v20, 16, v68
    v_and_b32 v21, 0xffff0000, v68
    v_lshlrev_b32 v22, 16, v70
    v_and_b32 v23, 0xffff0000, v70
    v_lshlrev_b32 v24, 16, v72
    v_and_b32 v25, 0xffff0000, v72
    s_mul_i32 s64, s96, 1280
    v_readfirstlane_b32 s31, v16
    s_nop 1
    v_subrev_f32 v28, s31, v16
    v_subrev_f32 v29, s31, v17
    v_add_f32 v27, v28, v29
    v_mul_f32 v26, v28, v28
    v_mul_f32 v31, v29, v29
    v_subrev_f32 v28, s31, v18
    v_subrev_f32 v29, s31, v19
    v_add_f32 v27, v27, v28
    v_fmac_f32 v26, v28, v28
    v_add_f32 v27, v27, v29
    v_fmac_f32 v31, v29, v29
    v_subrev_f32 v28, s31, v20
    v_subrev_f32 v29, s31, v21
    v_add_f32 v27, v27, v28
    v_fmac_f32 v26, v28, v28
    v_add_f32 v27, v27, v29
    v_fmac_f32 v31, v29, v29
    v_subrev_f32 v28, s31, v22
    v_subrev_f32 v29, s31, v23
    v_add_f32 v27, v27, v28
    v_fmac_f32 v26, v28, v28
    v_add_f32 v27, v27, v29
    v_fmac_f32 v31, v29, v29
    v_subrev_f32 v28, s31, v24
    v_subrev_f32 v29, s31, v25
    v_add_f32 v27, v27, v28
    v_fmac_f32 v26, v28, v28
    v_add_f32 v27, v27, v29
    v_fmac_f32 v31, v29, v29
    v_add_f32 v26, v26, v31
    v_add_f32_dpp v27, v27, v27 quad_perm:[1,0,3,2] row_mask:0xf bank_mask:0xf
    s_nop 0
    v_add_f32_dpp v26, v26, v26 quad_perm:[1,0,3,2] row_mask:0xf bank_mask:0xf
    v_add_f32_dpp v27, v27, v27 quad_perm:[2,3,0,1] row_mask:0xf bank_mask:0xf
    s_nop 0
    v_add_f32_dpp v26, v26, v26 quad_perm:[2,3,0,1] row_mask:0xf bank_mask:0xf
    v_add_f32_dpp v27, v27, v27 row_half_mirror row_mask:0xf bank_mask:0xf
    s_nop 0
    v_add_f32_dpp v26, v26, v26 row_half_mirror row_mask:0xf bank_mask:0xf
    v_add_f32_dpp v27, v27, v27 row_mirror row_mask:0xf bank_mask:0xf
    s_nop 0
    v_add_f32_dpp v26, v26, v26 row_mirror row_mask:0xf bank_mask:0xf
    s_nop 1
    v_permlane16_swap_b32 v27, v26
    v_add_f32 v27, v27, v26
    s_nop 0
    v_readlane_b32 s56, v27, 0
    v_readlane_b32 s57, v27, 32
    v_readlane_b32 s58, v27, 16
    v_readlane_b32 s59, v27, 48
    v_mov_b32 v27, s56
    v_mov_b32 v26, s58
    v_add_f32 v27, s57, v27
    v_add_f32 v26, s59, v26
    v_mul_f32 v27, 0x3acccccd, v27
    v_mul_f32 v26, 0x3acccccd, v26
    v_fma_f32 v26, -v27, v27, v26
    v_add_f32 v27, s31, v27
    v_max_f32 v26, 0, v26
    v_cvt_pk_bf16_f32 v28, v26, v27
    v_lshlrev_b32 v26, 16, v28
    v_and_b32 v27, 0xffff0000, v28
    v_add_f32 v26, 0x3727c5ac, v26
    v_cvt_pk_bf16_f32 v28, v26, v26
    v_lshlrev_b32 v26, 16, v28
    v_sqrt_f32 v26, v26
    s_nop 0
    v_cvt_pk_bf16_f32 v28, v26, v26
    v_lshlrev_b32 v26, 16, v28
    v_rcp_f32 v30, v26
    v_lshlrev_b32 v32, 2, v1
    v_add_u32 v32, s64, v32
    v_sub_f32 v16, v16, v27
    v_sub_f32 v17, v17, v27
    v_sub_f32 v18, v18, v27
    v_sub_f32 v19, v19, v27
    v_sub_f32 v20, v20, v27
    v_sub_f32 v21, v21, v27
    v_sub_f32 v22, v22, v27
    v_sub_f32 v23, v23, v27
    v_sub_f32 v24, v24, v27
    v_sub_f32 v25, v25, v27
    v_cvt_pk_bf16_f32 v28, v16, v17
    v_lshlrev_b32 v16, 16, v28
    v_and_b32 v17, 0xffff0000, v28
    v_mul_f32 v28, v16, v30
    v_mul_f32 v29, v17, v30
    v_fma_f32 v16, -v28, v26, v16
    v_fma_f32 v17, -v29, v26, v17
    v_fma_f32 v16, v16, v30, v28
    v_fma_f32 v17, v17, v30, v29
    v_cvt_pk_bf16_f32 v33, v16, v17
    ds_write_b32 v32, v33 offset:2560
    v_cvt_pk_bf16_f32 v28, v18, v19
    v_lshlrev_b32 v18, 16, v28
    v_and_b32 v19, 0xffff0000, v28
    v_mul_f32 v28, v18, v30
    v_mul_f32 v29, v19, v30
    v_fma_f32 v18, -v28, v26, v18
    v_fma_f32 v19, -v29, v26, v19
    v_fma_f32 v18, v18, v30, v28
    v_fma_f32 v19, v19, v30, v29
    v_cvt_pk_bf16_f32 v33, v18, v19
    ds_write_b32 v32, v33 offset:2816
    v_cvt_pk_bf16_f32 v28, v20, v21
    v_lshlrev_b32 v20, 16, v28
    v_and_b32 v21, 0xffff0000, v28
    v_mul_f32 v28, v20, v30
    v_mul_f32 v29, v21, v30
    v_fma_f32 v20, -v28, v26, v20
    v_fma_f32 v21, -v29, v26, v21
    v_fma_f32 v20, v20, v30, v28
    v_fma_f32 v21, v21, v30, v29
    v_cvt_pk_bf16_f32 v33, v20, v21
    ds_write_b32 v32, v33 offset:3072
    v_cvt_pk_bf16_f32 v28, v22, v23
    v_lshlrev_b32 v22, 16, v28
    v_and_b32 v23, 0xffff0000, v28
    v_mul_f32 v28, v22, v30
    v_mul_f32 v29, v23, v30
    v_fma_f32 v22, -v28, v26, v22
    v_fma_f32 v23, -v29, v26, v23
    v_fma_f32 v22, v22, v30, v28
    v_fma_f32 v23, v23, v30, v29
    v_cvt_pk_bf16_f32 v33, v22, v23
    ds_write_b32 v32, v33 offset:3328
    v_cvt_pk_bf16_f32 v28, v24, v25
    v_lshlrev_b32 v24, 16, v28
    v_and_b32 v25, 0xffff0000, v28
    v_mul_f32 v28, v24, v30
    v_mul_f32 v29, v25, v30
    v_fma_f32 v24, -v28, v26, v24
    v_fma_f32 v25, -v29, v26, v25
    v_fma_f32 v24, v24, v30, v28
    v_fma_f32 v25, v25, v30, v29
    v_cvt_pk_bf16_f32 v33, v24, v25
    ds_write_b32 v32, v33 offset:3584
L_F1_ln_done:
    v_and_b32 v58, 1, v1
    v_mul_u32_u24 v50, 1280, v58
    v_lshl_add_u32 v50, v42, 4, v50
    v_lshlrev_b32 v58, 7, v58
    v_lshl_add_u32 v58, v42, 4, v58
    v_and_b32 v59, 15, v1
    v_and_b32 v60, 1, v42
    v_mul_u32_u24 v61, 5120, v60
    v_lshl_add_u32 v61, v59, 3, v61
    s_mul_i32 s31, s61, 10240
    s_mul_i32 s62, s96, 640
    s_add_u32 s31, s31, s62
    s_add_u32 s31, s31, 2097152
    v_add_u32 v61, s31, v61
    v_mov_b32 v152, 0
    v_mov_b32 v153, 0
    v_mov_b32 v154, 0
    v_mov_b32 v155, 0
    s_waitcnt lgkmcnt(0)
    s_barrier
    s_cmp_lt_u32 s96, 4
    s_cbranch_scc1 L_F_h1done
    ds_read_b128 v[64:67], v50 offset:2560
    ds_read_b128 v[68:71], v50 offset:2624
    ds_read_b128 v[72:75], v50 offset:2688
    ds_read_b128 v[76:79], v50 offset:2752
    ds_read_b128 v[80:83], v50 offset:2816
    ds_read_b128 v[84:87], v50 offset:2880
    ds_read_b128 v[88:91], v50 offset:2944
    ds_read_b128 v[92:95], v50 offset:3008
    ds_read_b128 v[96:99], v50 offset:3072
    ds_read_b128 v[100:103], v50 offset:3136
    ds_read_b128 v[104:107], v50 offset:3200
    ds_read_b128 v[108:111], v50 offset:3264
    s_waitcnt lgkmcnt(11)
    v_mfma_f32_16x16x32_bf16 v[152:155], v[64:67], v[160:163], v[152:155]
    ds_read_b128 v[64:67], v50 offset:3328
    s_waitcnt lgkmcnt(11)
    v_mfma_f32_16x16x32_bf16 v[152:155], v[68:71], v[164:167], v[152:155]
    ds_read_b128 v[68:71], v50 offset:3392
    s_waitcnt lgkmcnt(11)
    v_mfma_f32_16x16x32_bf16 v[152:155], v[72:75], v[168:171], v[152:155]
    ds_read_b128 v[72:75], v50 offset:3456
    s_waitcnt lgkmcnt(11)
    v_mfma_f32_16x16x32_bf16 v[152:155], v[76:79], v[172:175], v[152:155]
    ds_read_b128 v[76:79], v50 offset:3520
    s_waitcnt lgkmcnt(11)
    v_mfma_f32_16x16x32_bf16 v[152:155], v[80:83], v[176:179], v[152:155]
    ds_read_b128 v[80:83], v50 offset:3584
    s_waitcnt lgkmcnt(11)
    v_mfma_f32_16x16x32_bf16 v[152:155], v[84:87], v[180:183], v[152:155]
    ds_read_b128 v[84:87], v50 offset:3648
    s_waitcnt lgkmcnt(11)
    v_mfma_f32_16x16x32_bf16 v[152:155], v[88:91], v[184:187], v[152:155]
    ds_read_b128 v[88:91], v50 offset:3712
    s_waitcnt lgkmcnt(11)
    v_mfma_f32_16x16x32_bf16 v[152:155], v[92:95], v[188:191], v[152:155]
    ds_read_b128 v[92:95], v50 offset:3776
    s_waitcnt lgkmcnt(11)
    v_mfma_f32_16x16x32_bf16 v[152:155], v[96:99], v[192:195], v[152:155]
    s_waitcnt lgkmcnt(10)
    v_mfma_f32_16x16x32_bf16 v[152:155], v[100:103], v[196:199], v[152:155]
    s_waitcnt lgkmcnt(9)
    v_mfma_f32_16x16x32_bf16 v[152:155], v[104:107], v[200:203], v[152:155]
    s_waitcnt lgkmcnt(8)
    v_mfma_f32_16x16x32_bf16 v[152:155], v[108:111], v[204:207], v[152:155]
    s_waitcnt lgkmcnt(7)
    v_mfma_f32_16x16x32_bf16 v[152:155], v[64:67], v[208:211], v[152:155]
    s_waitcnt lgkmcnt(6)
    v_mfma_f32_16x16x32_bf16 v[152:155], v[68:71], v[212:215], v[152:155]
    s_waitcnt lgkmcnt(5)
    v_mfma_f32_16x16x32_bf16 v[152:155], v[72:75], v[216:219], v[152:155]
    s_waitcnt lgkmcnt(4)
    v_mfma_f32_16x16x32_bf16 v[152:155], v[76:79], v[220:223], v[152:155]
    s_waitcnt lgkmcnt(3)
    v_mfma_f32_16x16x32_bf16 v[152:155], v[80:83], v[224:227], v[152:155]
    s_waitcnt lgkmcnt(2)
    v_mfma_f32_16x16x32_bf16 v[152:155], v[84:87], v[228:231], v[152:155]
    s_waitcnt lgkmcnt(1)
    v_mfma_f32_16x16x32_bf16 v[152:155], v[88:91], v[232:235], v[152:155]
    s_waitcnt lgkmcnt(0)
    v_mfma_f32_16x16x32_bf16 v[152:155], v[92:95], v[236:239], v[152:155]
    v_cmp_eq_u32 vcc, 1, v60
    s_and_b32 s62, s96, 3
    s_lshl_b32 s62, s62, 5
    v_lshlrev_b32 v57, 7, v60
    v_lshl_add_u32 v57, v59, 1, v57
    v_add_u32 v57, s62, v57
    s_nop 1
    v_cndmask_b32 v50, v152, v153, vcc
    v_cvt_pk_bf16_f32 v52, v50, v50
    v_lshlrev_b32 v50, 16, v52
    v_mul_f32 v52, 0xbfb8aa3b, v50
    v_exp_f32 v52, v52
    s_nop 0
    v_add_f32 v52, 1.0, v52
    v_rcp_f32 v54, v52
    v_cmp_nge_f32 vcc, 0xc2a00000, v50
    v_mul_f32 v56, v50, v54
    v_fma_f32 v55, -v56, v52, v50
    v_fma_f32 v56, v55, v54, v56
    v_cndmask_b32 v56, 0, v56, vcc
    v_cvt_pk_bf16_f32 v56, v56, v56
    ds_write_b16 v57, v56 offset:11648
L_F_h1done:
    v_mov_b32 v72, 0
    v_mov_b32 v73, 0
    v_mov_b32 v74, 0
    v_mov_b32 v75, 0
    v_mov_b32 v76, 0
    v_mov_b32 v77, 0
    v_mov_b32 v78, 0
    v_mov_b32 v79, 0
    v_mov_b32 v80, 0
    v_mov_b32 v81, 0
    v_mov_b32 v82, 0
    v_mov_b32 v83, 0
    v_mov_b32 v84, 0
    v_mov_b32 v85, 0
    v_mov_b32 v86, 0
    v_mov_b32 v87, 0
    v_mov_b32 v88, 0
    v_mov_b32 v89, 0
    v_mov_b32 v90, 0
    v_mov_b32 v91, 0
    v_cmp_eq_u32 vcc, 1, v60
    s_xor_b32 s31, s30, 1515847681
    v_mov_b32 v51, s31
    v_mov_b32 v53, s31
    s_waitcnt lgkmcnt(0)
    s_barrier
    ds_read_b128 v[64:67], v58 offset:11648
    ds_read_b128 v[68:71], v58 offset:11712
    s_waitcnt lgkmcnt(1)
    v_mfma_f32_16x16x32_bf16 v[72:75], v[64:67], v[112:115], v[72:75]
    v_mfma_f32_16x16x32_bf16 v[76:79], v[64:67], v[120:123], v[76:79]
    v_mfma_f32_16x16x32_bf16 v[80:83], v[64:67], v[128:131], v[80:83]
    v_mfma_f32_16x16x32_bf16 v[84:87], v[64:67], v[136:139], v[84:87]
    v_mfma_f32_16x16x32_bf16 v[88:91], v[64:67], v[144:147], v[88:91]
    s_waitcnt lgkmcnt(0)
    v_mfma_f32_16x16x32_bf16 v[72:75], v[68:71], v[116:119], v[72:75]
    v_mfma_f32_16x16x32_bf16 v[76:79], v[68:71], v[124:127], v[76:79]
    v_mfma_f32_16x16x32_bf16 v[80:83], v[68:71], v[132:135], v[80:83]
    v_mfma_f32_16x16x32_bf16 v[84:87], v[68:71], v[140:143], v[84:87]
    v_mfma_f32_16x16x32_bf16 v[88:91], v[68:71], v[148:151], v[88:91]
    s_mov_b32 exec_hi, 0
    s_nop 2
    v_cndmask_b32 v50, v72, v73, vcc
    global_store_dwordx2 v61, v[50:51], s[24:25] offset:0 sc1
    v_cndmask_b32 v52, v76, v77, vcc
    global_store_dwordx2 v61, v[52:53], s[24:25] offset:128 sc1
    v_cndmask_b32 v50, v80, v81, vcc
    global_store_dwordx2 v61, v[50:51], s[24:25] offset:256 sc1
    v_cndmask_b32 v52, v84, v85, vcc
    global_store_dwordx2 v61, v[52:53], s[24:25] offset:384 sc1
    v_cndmask_b32 v50, v88, v89, vcc
    global_store_dwordx2 v61, v[50:51], s[24:25] offset:512 sc1
    s_mov_b64 exec, s[14:15]
    s_sub_u32 s31, s96, 2
    s_cmp_ge_u32 s31, 2
    s_cbranch_scc1 L_end
    s_cmp_ge_u32 s61, 0
    s_cbranch_scc1 L_end
L_Eunit:
    v_add_u32 v96, 0, v96
    v_add_u32 v97, 0, v97
    v_add_u32 v98, 0, v98
    v_add_u32 v99, 0, v99
    v_add_u32 v100, 0, v100
    v_add_u32 v101, 0, v101
    s_lshl_b32 s62, s61, 1
    s_add_u32 s62, s62, s31
    s_lshl_b32 s63, s62, 5
    v_bfe_u32 v54, v1, 3, 1
    v_mul_u32_u24 v54, 1280, v54
    v_lshl_add_u32 v54, v3, 2, v54
    v_add_u32 v54, s63, v54
    s_xor_b32 s30, s30, 1515847681
    s_mov_b64 s[68:69], exec
    s_mov_b32 s53, 1048576
L_poll_22:
    global_load_dwordx4 v[64:67], v96, s[24:25] sc1
    global_load_dwordx4 v[68:71], v97, s[24:25] sc1
    global_load_dwordx4 v[72:75], v98, s[24:25] sc1
    global_load_dwordx4 v[76:79], v99, s[24:25] sc1
    global_load_dwordx4 v[80:83], v100, s[24:25] sc1
    global_load_dwordx4 v[84:87], v101, s[24:25] sc1
    s_waitcnt vmcnt(0)
    v_min_u32 v56, v65, v67
    v_max_u32 v57, v65, v67
    v_min3_u32 v56, v56, v69, v71
    v_max3_u32 v57, v57, v69, v71
    v_min3_u32 v56, v56, v73, v75
    v_max3_u32 v57, v57, v73, v75
    v_min3_u32 v56, v56, v77, v79
    v_max3_u32 v57, v57, v77, v79
    v_min3_u32 v56, v56, v81, v83
    v_max3_u32 v57, v57, v81, v83
    v_min3_u32 v56, v56, v85, v87
    v_max3_u32 v57, v57, v85, v87
    v_xor_b32 v56, s30, v56
    v_xor_b32 v57, s30, v57
    v_or_b32 v56, v56, v57
    v_cmp_ne_u32 vcc, 0, v56
    s_nop 0
    s_and_b64 exec, exec, vcc
    s_cbranch_execz L_polldone_23
    s_sub_u32 s53, s53, 1
    s_cbranch_scc1 L_polldone_23
    s_sleep 1
    s_branch L_poll_22
L_polldone_23:
    s_mov_b64 exec, s[68:69]
    s_xor_b32 s30, s30, 1515847681
    v_add_f32 v64, v64, v68
    v_add_f32 v66, v66, v70
    v_add_f32 v72, v72, v76
    v_add_f32 v74, v74, v78
    v_add_f32 v80, v80, v84
    v_add_f32 v82, v82, v86
    v_add_f32 v64, v64, v72
    v_add_f32 v66, v66, v74
    v_add_f32 v64, v64, v80
    v_add_f32 v66, v66, v82
    v_mov_b32 v65, v64
    v_mov_b32 v67, v66
    s_nop 0
    v_permlane16_swap_b32 v64, v65
    v_permlane16_swap_b32 v66, v67
    v_add_f32 v64, v64, v65
    v_add_f32 v66, v66, v67
    v_mov_b32 v65, v64
    v_mov_b32 v67, v66
    s_nop 0
    v_permlane32_swap_b32 v64, v65
    v_permlane32_swap_b32 v66, v67
    v_add_f32 v64, v64, v65
    v_add_f32 v66, v66, v67
    v_cvt_pk_bf16_f32 v68, v64, v66
    v_lshlrev_b32 v64, 16, v68
    v_and_b32 v65, 0xffff0000, v68
    v_lshlrev_b32 v66, 16, v63
    v_and_b32 v67, 0xffff0000, v63
    v_add_f32 v64, v64, v66
    v_add_f32 v65, v65, v67
    v_cvt_pk_bf16_f32 v68, v64, v65
    s_and_b64 exec, s[14:15], 0xffff
    global_store_dword v54, v68, s[20:21]
    s_cmp_lg_u32 s62, 0
    s_cbranch_scc1 L_end
    s_and_b64 exec, s[14:15], 1
    v_mov_b32 v51, s30
    global_store_dword v45, v51, s[24:25] sc1
L_end:
L_exit:
    s_endpgm
.section .rodata,"a"
.p2align 6
.amdhsa_kernel sequential_preLN__mha_block_cached__dense_activation_silu__decode_kernel
  .amdhsa_next_free_vgpr 240
  .amdhsa_next_free_sgpr 100
  .amdhsa_accum_offset 240
  .amdhsa_group_segment_fixed_size 0
  .amdhsa_kernarg_size 88
  .amdhsa_user_sgpr_count 2
  .amdhsa_user_sgpr_kernarg_segment_ptr 1
  .amdhsa_system_sgpr_workgroup_id_x 1
.end_amdhsa_kernel
```
